```python
import torch

def _softmax(x, axis=-1):
    return torch.softmax(x, dim=axis)
def _gelu(x):
    return torch.nn.functional.gelu(x, approximate="tanh")
def _silu(x):
    return torch.nn.functional.silu(x)
def _sigmoid(x):
    return torch.sigmoid(x)
def _layernorm(x, axis=-1, eps=1e-5):
    m = x.mean(dim=axis, keepdim=True)
    v = x.var(dim=axis, keepdim=True, unbiased=False)
    return (x - m) / torch.sqrt(v + eps)
def _scatter_add(tgt, idx, src, axis=0):
    return tgt.clone().index_add_(axis, idx, src)
def _segment_sum(src, seg, n):
    out = torch.zeros((n,) + src.shape[1:], dtype=src.dtype)
    return out.index_add_(0, seg, src)
def _pad(x, pw):
    flat = tuple(v for pair in reversed(pw) for v in pair)
    return torch.nn.functional.pad(x, flat)

kernel_name = 'concat_heads__compressed_kv_cla__gqa_block_cached__decode'

def setup_inputs():

    _w = (lambda a: (lambda t: t.to(torch.bfloat16) if t.is_floating_point() else t)(torch.as_tensor(a)))
    def _A_setup():
        B, H, Sq, Sk, D, M = 2, 32, 1, 8192, 128, 512
        Dc = 4 * D
        return {
            "x": _w((lambda *s: torch.randn(*s, dtype=torch.bfloat16) * 3.2)(B, Sq, M)),
            "c_kv": _w((lambda *s: torch.randn(*s, dtype=torch.bfloat16) * 0.1)(B, Sk, Dc)),
            "w_q": _w((lambda *s: torch.randn(*s, dtype=torch.bfloat16) * 6.4)(M, H, D) * (M ** -0.5)),
            "w_uk": _w((lambda *s: torch.randn(*s, dtype=torch.bfloat16) * 6.4)(Dc, H, D) * (Dc ** -0.5)),
            "w_uv": _w((lambda *s: torch.randn(*s, dtype=torch.bfloat16) * 0.1)(Dc, H, D) * (Dc ** -0.5)),
            "w_o": _w((lambda *s: torch.randn(*s, dtype=torch.bfloat16) * 0.1)(H, D, M) * ((H * D) ** -0.5)),
        }
    _A_in = _A_setup()

    def _B_setup():
        B, Sq, D = 2, 1, 512
        Hq, Hkv, Sk, Dh = 32, 8, 8192, 128
        assert Hq % Hkv == 0, (Hq, Hkv)
        return {
            "x": _w((lambda *s: torch.randn(*s, dtype=torch.bfloat16) * 1.6)(B, Sq, D)),
            "k_cache": _w((lambda *s: torch.randn(*s, dtype=torch.bfloat16) * 1.6)(B, Hkv, Sk, Dh)),
            "v_cache": _w((lambda *s: torch.randn(*s, dtype=torch.bfloat16) * 0.05)(B, Hkv, Sk, Dh)),
            "wq": _w((lambda *s: torch.randn(*s, dtype=torch.bfloat16) * 1.6)(D, Hq * Dh) * (D ** -0.5)),
            "wo": _w((lambda *s: torch.randn(*s, dtype=torch.bfloat16) * 0.05)(Hq * Dh, D) * ((Hq * Dh) ** -0.5)),
        }
    _B_in = _B_setup()

    return {
        "A_x": _A_in["x"],
        "A_c_kv": _A_in["c_kv"],
        "A_w_q": _A_in["w_q"],
        "A_w_uk": _A_in["w_uk"],
        "A_w_uv": _A_in["w_uv"],
        "A_w_o": _A_in["w_o"],
        "B_x": _B_in["x"],
        "B_k_cache": _B_in["k_cache"],
        "B_v_cache": _B_in["v_cache"],
        "B_wq": _B_in["wq"],
        "B_wo": _B_in["wo"],
    }

def reference(A_x, A_c_kv, A_w_q, A_w_uk, A_w_uv, A_w_o, B_x, B_k_cache, B_v_cache, B_wq, B_wo):
    def _A_ref(x, c_kv, w_q, w_uk, w_uv, w_o):
        B, Sq, M = x.shape[0], x.shape[1], x.shape[2]
        Sk = c_kv.shape[1]
        H, D = w_q.shape[1], w_q.shape[2]
        q = torch.einsum("bqm,mhd->bhqd", x, w_q)
        k = torch.einsum("bkc,chd->bhkd", c_kv, w_uk)
        v = torch.einsum("bkc,chd->bhkd", c_kv, w_uv)
        scores = torch.einsum("bhqd,bhkd->bhqk", q, k) * (D ** -0.5)
        off = Sk - Sq
        qi = torch.arange(Sq)[:, None]
        kj = torch.arange(Sk)[None, :]
        cmask = kj <= (qi + off)
        scores = torch.where(cmask[None, None], scores, -1e9)
        p = _softmax(scores, axis=-1)
        ctx = torch.einsum("bhqk,bhkd->bhqd", p, v)
        return torch.einsum("bhqd,hdm->bqm", ctx, w_o)

    def _B_ref(x, k_cache, v_cache, wq, wo):
        B, Sq, D = x.shape
        Hq, Dh = 32, 128
        Hkv = k_cache.shape[1]
        rep = Hq // Hkv
        q = (lambda x, *d: x.permute(*d))((x @ wq).reshape(B, Sq, Hq, Dh), 0, 2, 1, 3)
        k = (lambda x, n, axis: torch.repeat_interleave(x, n, dim=axis))(k_cache, rep, axis=1)
        v = (lambda x, n, axis: torch.repeat_interleave(x, n, dim=axis))(v_cache, rep, axis=1)
        scores = torch.einsum("bhqd,bhkd->bhqk", q, k) * (Dh ** -0.5)
        p = _softmax(scores, axis=-1)
        o = torch.einsum("bhqk,bhkd->bhqd", p, v)
        return (lambda x, *d: x.permute(*d))(o, 0, 2, 1, 3).reshape(B, Sq, Hq * Dh) @ wo

    a = _A_ref(A_x, A_c_kv, A_w_q, A_w_uk, A_w_uv, A_w_o)
    b = _B_ref(B_x, B_k_cache, B_v_cache, B_wq, B_wo)
    return torch.concatenate([a, b], axis=-1)
```

```asm
; @launch grid=(256,1,1) block=(512,1,1) lds=163840
.amdgcn_target "amdgcn-amd-amdhsa--gfx950"
.text
.globl concat_heads__compressed_kv_cla__gqa_block_cached__decode_kernel
.p2align 8
.type concat_heads__compressed_kv_cla__gqa_block_cached__decode_kernel,@function
concat_heads__compressed_kv_cla__gqa_block_cached__decode_kernel:
    s_cmp_ge_u32 s2, 256
    s_cbranch_scc1 L_END
    s_load_dwordx16 s[16:31], s[0:1], 0
    s_load_dwordx8 s[32:39], s[0:1], 64
    s_load_dwordx4 s[40:43], s[0:1], 96
    v_lshrrev_b32 v1, 6, v0
    v_and_b32 v0, 63, v0
    v_readfirstlane_b32 s3, v1
    s_sub_u32 s4, s2, 128
    s_cmp_ge_u32 s3, 4
    s_cselect_b32 s5, s4, 64
    s_cmp_ge_u32 s5, 64
    s_cbranch_scc0 L_AL
    s_cmp_ge_u32 s2, 192
    s_cbranch_scc1 L_Q
    s_cmp_lt_u32 s3, 4
    s_cselect_b32 s5, s4, 64
    s_cmp_lt_u32 s5, 64
    s_cbranch_scc1 L_AC
L_P:
    v_and_b32 v24, 3, v0
    v_lshrrev_b32 v3, 4, v0
    v_lshlrev_b32 v25, 6, v3
    v_lshl_add_u32 v25, v24, 4, v25
    v_bfe_u32 v24, v0, 2, 2
    v_lshl_add_u32 v1, v24, 8, v25
    v_lshlrev_b32 v2, 4, v0
    v_lshl_add_u32 v30, v24, 15, v25
    v_and_b32 v28, 15, v0
    v_lshlrev_b32 v28, 4, v28
    v_lshl_add_u32 v28, v3, 15, v28
    v_bfe_u32 v29, v0, 3, 1
    v_lshlrev_b32 v29, 10, v29
    v_lshl_add_u32 v29, v3, 3, v29
    s_lshr_b32 s10, s2, 3
    s_and_b32 s9, s2, 7
    s_mul_i32 s11, s9, 48
    s_lshr_b32 s13, s2, 2
    s_and_b32 s4, s2, 3
    s_lshl_b32 s11, s11, 12
    s_lshl_b32 s12, s3, 10
    s_add_u32 s11, s11, s12
    s_and_b32 s7, s10, 7
    s_lshr_b32 s8, s10, 3
    s_lshl_b32 s10, s10, 21
    s_add_u32 s5, s10, s11
    s_mov_b32 s6, s5
    s_lshl_b32 s10, s4, 7
    s_lshl_b32 s11, s3, 4
    s_add_u32 s10, s10, s11
    s_lshl_b32 s11, s10, 1
    s_lshl_b32 s10, s10, 13
    s_lshl_b32 s12, s13, 8
    s_add_u32 s10, s10, s12
    s_mov_b32 s46, 0x500000
    s_mov_b32 s47, 0x20000
    s_mov_b32 s58, 0x800
    s_mov_b32 s59, 0x20000
    s_mov_b32 s62, 0x400000
    s_mov_b32 s63, 0x20000
    s_waitcnt lgkmcnt(0)
    s_mov_b32 s44, s42
    s_mov_b32 s45, s43
    s_mov_b32 s56, s16
    s_mov_b32 s57, s17
    s_mov_b32 s60, s20
    s_mov_b32 s61, s21
    v_lshlrev_b32 v22, 15, v3
    v_and_b32 v251, 15, v0
    v_lshl_add_u32 v22, v251, 4, v22
    s_cmp_lg_u32 s3, 7
    s_cbranch_scc1 L_skip_1
    s_lshl_b32 s12, s2, 8
    s_add_u32 s12, s12, 131072
    v_mov_b32 v246, -1
    v_mov_b32 v247, -1
    v_mov_b32 v248, -1
    v_mov_b32 v249, -1
    s_mov_b32 exec_hi, 0
    buffer_store_dwordx4 v[246:249], v22, s[44:47], s12 offen sc1
    s_mov_b64 exec, -1
L_skip_1:
    buffer_load_dwordx2 v[24:25], v29, s[56:59], s11 offen
    s_mov_b32 s12, s10
    buffer_load_dwordx4 v[132:135], v28, s[60:63], s12 offen nt
    s_add_u32 s12, s12, 8192
    buffer_load_dwordx4 v[136:139], v28, s[60:63], s12 offen nt
    s_add_u32 s12, s12, 8192
    buffer_load_dwordx4 v[140:143], v28, s[60:63], s12 offen nt
    s_add_u32 s12, s12, 8192
    buffer_load_dwordx4 v[144:147], v28, s[60:63], s12 offen nt
    s_mov_b32 s64, s22
    s_mov_b32 s65, s23
    s_mov_b32 s66, 0x400000
    s_mov_b32 s67, 0x20000
    s_waitcnt vmcnt(3)
    s_mov_b32 s12, s10
    buffer_load_dwordx4 v[148:151], v30, s[64:67], s12 offen nt
    s_add_u32 s12, s12, 8192
    buffer_load_dwordx4 v[152:155], v30, s[64:67], s12 offen nt
    s_add_u32 s12, s12, 8192
    buffer_load_dwordx4 v[156:159], v30, s[64:67], s12 offen nt
    s_add_u32 s12, s12, 8192
    buffer_load_dwordx4 v[160:163], v30, s[64:67], s12 offen nt
    s_mov_b32 s48, s30
    s_mov_b32 s49, s31
    s_mov_b32 s50, 0x2000000
    s_mov_b32 s51, 0x20000
    s_mov_b32 s52, s32
    s_mov_b32 s53, s33
    s_mov_b32 s54, 0x2000000
    s_mov_b32 s55, 0x20000
    s_load_dword s94, s[42:43], 0x60000
    s_branch L_P_REST
L_AL:
    s_sub_u32 s5, s3, 4
    s_and_b32 s10, s3, 1
    s_lshl_b32 s10, s10, 5
    v_lshlrev_b32 v1, 4, v0
    v_xor_b32 v10, s10, v1
    v_xor_b32 v232, 0, v10
    v_xor_b32 v233, 64, v10
    v_xor_b32 v234, 128, v10
    v_xor_b32 v235, 192, v10
    v_xor_b32 v236, 16, v10
    v_xor_b32 v237, 80, v10
    v_xor_b32 v238, 144, v10
    v_xor_b32 v239, 208, v10
    s_lshl_b32 s66, s4, 18
    s_lshl_b32 s67, s5, 13
    s_add_u32 s66, s66, s67
    s_mov_b32 s50, 0x1000000
    s_mov_b32 s51, 0x20000
    s_waitcnt lgkmcnt(0)
    s_mov_b32 s48, s18
    s_mov_b32 s49, s19
    s_mov_b32 m0, s67
    s_nop 0
    buffer_load_dwordx4 v232, s[48:51], s66 offen offset:0 nt lds
    buffer_load_dwordx4 v233, s[48:51], s66 offen offset:1024 nt lds
    buffer_load_dwordx4 v234, s[48:51], s66 offen offset:2048 nt lds
    buffer_load_dwordx4 v235, s[48:51], s66 offen offset:3072 nt lds
    s_add_u32 s66, s66, 4096
    s_add_u32 s67, s67, 4096
    s_mov_b32 m0, s67
    s_nop 0
    buffer_load_dwordx4 v236, s[48:51], s66 offen offset:0 nt lds
    buffer_load_dwordx4 v237, s[48:51], s66 offen offset:1024 nt lds
    buffer_load_dwordx4 v238, s[48:51], s66 offen offset:2048 nt lds
    buffer_load_dwordx4 v239, s[48:51], s66 offen offset:3072 nt lds
    s_add_u32 s66, s66, 28672
    s_add_u32 s67, s67, 0x7000
    s_branch L_L_REST
L_Q:
    v_and_b32 v24, 3, v0
    v_lshrrev_b32 v3, 4, v0
    v_lshlrev_b32 v25, 6, v3
    v_lshl_add_u32 v25, v24, 4, v25
    v_bfe_u32 v24, v0, 2, 2
    v_lshl_add_u32 v1, v24, 8, v25
    v_lshlrev_b32 v2, 4, v0
    s_sub_u32 s4, s2, 192
    s_lshr_b32 s10, s4, 2
    s_and_b32 s4, s4, 3
    s_add_u32 s9, s4, 8
    s_mul_i32 s11, s4, 32
    s_add_u32 s11, s11, 384
    v_and_b32 v28, 15, v0
    v_lshlrev_b32 v28, 4, v28
    v_lshl_add_u32 v28, v3, 16, v28
    v_bfe_u32 v29, v0, 3, 1
    v_lshlrev_b32 v29, 10, v29
    v_lshl_add_u32 v29, v3, 4, v29
    s_sub_u32 s13, s2, 192
    s_and_b32 s4, s13, 1
    s_lshr_b32 s13, s13, 1
    s_xor_b32 s13, s13, 2
    s_lshl_b32 s11, s11, 12
    s_sub_u32 s12, s9, 8
    s_mul_i32 s12, s12, 8192
    s_add_u32 s11, s11, s12
    s_lshl_b32 s12, s3, 10
    s_add_u32 s11, s11, s12
    s_and_b32 s7, s10, 7
    s_lshr_b32 s8, s10, 3
    s_lshl_b32 s10, s10, 21
    s_add_u32 s5, s10, s11
    s_mov_b32 s6, s5
    s_lshl_b32 s10, s4, 8
    s_lshl_b32 s11, s3, 5
    s_add_u32 s10, s10, s11
    s_lshl_b32 s11, s10, 1
    s_lshl_b32 s10, s10, 13
    s_lshl_b32 s12, s13, 8
    s_add_u32 s10, s10, s12
    s_mov_b32 s46, 0x500000
    s_mov_b32 s47, 0x20000
    s_mov_b32 s58, 0x800
    s_mov_b32 s59, 0x20000
    s_mov_b32 s62, 0x400000
    s_mov_b32 s63, 0x20000
    s_waitcnt lgkmcnt(0)
    s_mov_b32 s44, s42
    s_mov_b32 s45, s43
    s_mov_b32 s56, s28
    s_mov_b32 s57, s29
    s_mov_b32 s60, s34
    s_mov_b32 s61, s35
    buffer_load_dwordx4 v[24:27], v29, s[56:59], s11 offen
    buffer_load_dwordx4 v[132:135], v28, s[60:63], s10 offen nt
    s_add_u32 s10, s10, 8192
    buffer_load_dwordx4 v[136:139], v28, s[60:63], s10 offen nt
    s_add_u32 s10, s10, 8192
    buffer_load_dwordx4 v[140:143], v28, s[60:63], s10 offen nt
    s_add_u32 s10, s10, 8192
    buffer_load_dwordx4 v[144:147], v28, s[60:63], s10 offen nt
    s_add_u32 s10, s10, 8192
    buffer_load_dwordx4 v[148:151], v28, s[60:63], s10 offen nt
    s_add_u32 s10, s10, 8192
    buffer_load_dwordx4 v[152:155], v28, s[60:63], s10 offen nt
    s_add_u32 s10, s10, 8192
    buffer_load_dwordx4 v[156:159], v28, s[60:63], s10 offen nt
    s_add_u32 s10, s10, 8192
    buffer_load_dwordx4 v[160:163], v28, s[60:63], s10 offen nt
    s_mov_b32 s64, s38
    s_mov_b32 s65, s39
    s_mov_b32 s66, 0x1000
    s_mov_b32 s67, 0x20000
    v_lshrrev_b32 v30, 3, v0
    v_lshlrev_b32 v30, 17, v30
    v_and_b32 v246, 7, v0
    v_lshl_add_u32 v30, v246, 4, v30
    v_and_b32 v246, 15, v0
    v_lshlrev_b32 v246, 4, v246
    v_lshl_add_u32 v246, v3, 14, v246
    s_sub_u32 s68, s2, 192
    s_cmp_lt_u32 s3, 4
    s_cselect_b32 s56, s24, s26
    s_cselect_b32 s57, s25, s27
    s_mov_b32 s58, 0x400000
    s_movk_i32 s69, 1024
    s_cselect_b32 s69, 8192, s69
    s_cselect_b64 vcc, -1, 0
    v_cndmask_b32 v30, v246, v30, vcc
    s_lshl_b32 s10, s3, 20
    s_lshl_b32 s11, s68, 7
    s_add_u32 s10, s10, s11
    s_lshl_b32 s11, s68, 16
    s_and_b32 s12, s3, 3
    s_lshl_b32 s12, s12, 8
    s_add_u32 s11, s11, s12
    s_cmp_lt_u32 s3, 4
    s_cselect_b32 s70, s10, s11
    s_lshl_b32 s71, s3, 14
    s_add_u32 s71, s71, 32768
    s_mov_b32 s48, s30
    s_mov_b32 s49, s31
    s_mov_b32 s50, 0x2000000
    s_mov_b32 s51, 0x20000
    s_mov_b32 s52, s32
    s_mov_b32 s53, s33
    s_mov_b32 s54, 0x2000000
    s_mov_b32 s55, 0x20000
    s_load_dword s94, s[42:43], 0x60000
    s_branch L_Q_REST
L_AC:
    s_branch L_C_REST
L_P_REST:
    s_mov_b32 s15, 0x3e0293ee
    s_mov_b32 s14, 20000
    v_and_b32 v3, 1, v0
    v_cmp_eq_u32 vcc, 1, v3
    v_mov_b32 v8, 0x0c0c0100
    v_mov_b32 v3, 0x01000c0c
    v_cndmask_b32 v8, v8, v3, vcc
    v_add_u32 v9, 0x0202, v8
    v_mov_b32 v3, 0x03020c0c
    v_cndmask_b32 v9, v9, v3, vcc
    v_and_b32 v3, 2, v0
    v_cmp_eq_u32 vcc, 0, v3
    v_mov_b32 v3, 0x0c0c0c0c
    s_nop 0
    v_cndmask_b32 v4, v3, v8, vcc
    v_cndmask_b32 v5, v8, v3, vcc
    v_cndmask_b32 v6, v3, v9, vcc
    v_cndmask_b32 v7, v9, v3, vcc
    v_mov_b32 v14, 0
    v_mov_b32 v15, 0
    ds_write_b64 v14, v[14:15] offset:9472
    s_waitcnt lgkmcnt(0)
    s_add_u32 s94, s94, 1
    s_xor_b32 s95, s94, 0x5bd1e995
    s_mov_b32 s72, 0x3030303
    s_mov_b32 s73, 0x3030303
    s_mov_b32 s74, 0xc0c0c0c
    s_mov_b32 s75, 0xc0c0c0c
    s_mov_b32 s76, 0x30303030
    s_mov_b32 s77, 0x30303030
    s_mov_b32 s78, 0xc0c0c0c0
    s_mov_b32 s79, 0xc0c0c0c0
    s_cmp_lg_u32 s3, 7
    s_cbranch_scc1 L_skip_2
    s_waitcnt vmcnt(9)
    v_lshlrev_b32 v248, 11, v0
    v_mov_b32 v246, s94
    v_mov_b32 v247, s95
    s_lshl_b32 s10, s2, 3
    s_add_u32 s10, s10, 524288
    s_mov_b64 exec, 255
    buffer_store_dwordx2 v[246:247], v248, s[44:47], s10 offen sc1
    s_mov_b64 exec, -1
L_skip_2:
    s_lshl_b32 s10, s3, 10
    v_add_u32 v31, s10, v2
    s_waitcnt vmcnt(8)
    v_perm_b32 v228, v24, v24, v8
    v_cndmask_b32 v230, 0, v228, s[72:73]
    v_cndmask_b32 v231, 0, v228, s[74:75]
    v_cndmask_b32 v232, 0, v228, s[76:77]
    v_cndmask_b32 v233, 0, v228, s[78:79]
    s_waitcnt vmcnt(7)
    s_nop 0
    v_mfma_f32_16x16x32_bf16 v[14:17], v[230:233], v[132:135], 0
    v_perm_b32 v228, v24, v24, v9
    v_cndmask_b32 v234, 0, v228, s[72:73]
    v_cndmask_b32 v235, 0, v228, s[74:75]
    v_cndmask_b32 v236, 0, v228, s[76:77]
    v_cndmask_b32 v237, 0, v228, s[78:79]
    s_waitcnt vmcnt(6)
    s_nop 0
    v_mfma_f32_16x16x32_bf16 v[14:17], v[234:237], v[136:139], v[14:17]
    v_perm_b32 v228, v25, v25, v8
    v_cndmask_b32 v230, 0, v228, s[72:73]
    v_cndmask_b32 v231, 0, v228, s[74:75]
    v_cndmask_b32 v232, 0, v228, s[76:77]
    v_cndmask_b32 v233, 0, v228, s[78:79]
    s_waitcnt vmcnt(5)
    s_nop 0
    v_mfma_f32_16x16x32_bf16 v[14:17], v[230:233], v[140:143], v[14:17]
    v_perm_b32 v228, v25, v25, v9
    v_cndmask_b32 v234, 0, v228, s[72:73]
    v_cndmask_b32 v235, 0, v228, s[74:75]
    v_cndmask_b32 v236, 0, v228, s[76:77]
    v_cndmask_b32 v237, 0, v228, s[78:79]
    s_waitcnt vmcnt(4)
    s_nop 0
    v_mfma_f32_16x16x32_bf16 v[14:17], v[234:237], v[144:147], v[14:17]
    s_nop 7
    ds_write_b128 v31, v[14:17] offset:32768
    s_waitcnt lgkmcnt(0)
    s_barrier
    s_cmp_lg_u32 s3, 0
    s_cbranch_scc1 L_skip_3
    ds_read_b128 v[180:183], v2 offset:32768
    ds_read_b128 v[184:187], v2 offset:33792
    ds_read_b128 v[188:191], v2 offset:34816
    ds_read_b128 v[192:195], v2 offset:35840
    ds_read_b128 v[196:199], v2 offset:36864
    ds_read_b128 v[200:203], v2 offset:37888
    ds_read_b128 v[204:207], v2 offset:38912
    ds_read_b128 v[208:211], v2 offset:39936
    v_mov_b32 v247, s95
    s_lshl_b32 s10, s2, 11
    s_add_u32 s10, s10, 4194304
    s_mov_b32 s11, 0xffffff00
    s_waitcnt lgkmcnt(0)
    v_add_f32 v180, v180, v184
    v_add_f32 v181, v181, v185
    v_add_f32 v182, v182, v186
    v_add_f32 v183, v183, v187
    v_add_f32 v188, v188, v192
    v_add_f32 v189, v189, v193
    v_add_f32 v190, v190, v194
    v_add_f32 v191, v191, v195
    v_add_f32 v196, v196, v200
    v_add_f32 v197, v197, v201
    v_add_f32 v198, v198, v202
    v_add_f32 v199, v199, v203
    v_add_f32 v204, v204, v208
    v_add_f32 v205, v205, v209
    v_add_f32 v206, v206, v210
    v_add_f32 v207, v207, v211
    v_add_f32 v180, v180, v188
    v_add_f32 v181, v181, v189
    v_add_f32 v182, v182, v190
    v_add_f32 v183, v183, v191
    v_add_f32 v196, v196, v204
    v_add_f32 v197, v197, v205
    v_add_f32 v198, v198, v206
    v_add_f32 v199, v199, v207
    v_add_f32 v180, v180, v196
    v_add_f32 v181, v181, v197
    v_add_f32 v182, v182, v198
    v_add_f32 v183, v183, v199
    v_bfi_b32 v188, s11, v180, v247
    v_mov_b32 v189, s94
    v_bfi_b32 v190, s11, v181, v247
    v_mov_b32 v191, s94
    v_bfi_b32 v192, s11, v182, v247
    v_mov_b32 v193, s94
    v_bfi_b32 v194, s11, v183, v247
    v_mov_b32 v195, s94
    buffer_store_dwordx4 v[188:191], v2, s[44:47], s10 offen sc1
    buffer_store_dwordx4 v[192:195], v2, s[44:47], s10 offen offset:1024 sc1
L_skip_3:
    buffer_load_dwordx4 v[36:39], v1, s[48:51], s5 offen offset:0 nt
    s_add_u32 s5, s5, 8192
    buffer_load_dwordx4 v[40:43], v1, s[48:51], s5 offen offset:0 nt
    s_add_u32 s5, s5, 8192
    buffer_load_dwordx4 v[44:47], v1, s[48:51], s5 offen offset:0 nt
    s_add_u32 s5, s5, 8192
    buffer_load_dwordx4 v[48:51], v1, s[48:51], s5 offen offset:0 nt
    s_add_u32 s5, s5, 8192
    s_waitcnt vmcnt(3)
    buffer_load_dwordx4 v[52:55], v1, s[48:51], s5 offen offset:0 nt
    s_add_u32 s5, s5, 8192
    s_waitcnt vmcnt(3)
    buffer_load_dwordx4 v[56:59], v1, s[48:51], s5 offen offset:0 nt
    s_add_u32 s5, s5, 8192
    s_waitcnt vmcnt(3)
    buffer_load_dwordx4 v[60:63], v1, s[48:51], s5 offen offset:0 nt
    s_add_u32 s5, s5, 8192
    s_waitcnt vmcnt(3)
    buffer_load_dwordx4 v[64:67], v1, s[48:51], s5 offen offset:0 nt
    s_add_u32 s5, s5, 8192
    s_lshr_b32 s10, s3, 1
    s_cmp_lg_u32 s10, 2
    s_cbranch_scc1 L_other_5
    s_lshl_b32 s10, s13, 13
    s_and_b32 s12, s3, 1
    s_lshl_b32 s11, s12, 10
    s_add_u32 s10, s10, s11
    s_add_u32 s10, s10, 4194304
    s_add_u32 s11, s10, 4096
    v_mov_b32 v247, 0xff
    v_lshrrev_b32 v249, 5, v0
    v_lshlrev_b32 v249, 8, v249
    v_and_b32 v250, 15, v0
    v_lshl_add_u32 v249, v250, 4, v249
    v_bfe_u32 v250, v0, 4, 1
    v_lshl_add_u32 v249, v250, 3, v249
    s_lshl_b32 s12, s12, 2
    v_add_u32 v249, s12, v249
L_spin_6:
    buffer_load_dwordx4 v[132:135], v2, s[44:47], s10 offen offset:0 sc1
    buffer_load_dwordx4 v[136:139], v2, s[44:47], s10 offen offset:2048 sc1
    buffer_load_dwordx4 v[140:143], v2, s[44:47], s11 offen offset:0 sc1
    buffer_load_dwordx4 v[144:147], v2, s[44:47], s11 offen offset:2048 sc1
    s_waitcnt vmcnt(0)
    v_xor_b32 v248, s95, v132
    v_xor_b32 v133, s94, v133
    v_and_or_b32 v133, v248, v247, v133
    v_xor_b32 v248, s95, v134
    v_xor_b32 v135, s94, v135
    v_and_or_b32 v135, v248, v247, v135
    v_xor_b32 v248, s95, v136
    v_xor_b32 v137, s94, v137
    v_and_or_b32 v137, v248, v247, v137
    v_xor_b32 v248, s95, v138
    v_xor_b32 v139, s94, v139
    v_and_or_b32 v139, v248, v247, v139
    v_xor_b32 v248, s95, v140
    v_xor_b32 v141, s94, v141
    v_and_or_b32 v141, v248, v247, v141
    v_xor_b32 v248, s95, v142
    v_xor_b32 v143, s94, v143
    v_and_or_b32 v143, v248, v247, v143
    v_xor_b32 v248, s95, v144
    v_xor_b32 v145, s94, v145
    v_and_or_b32 v145, v248, v247, v145
    v_xor_b32 v248, s95, v146
    v_xor_b32 v147, s94, v147
    v_and_or_b32 v147, v248, v247, v147
    v_or_b32 v246, v133, v135
    v_or3_b32 v246, v246, v137, v139
    v_or3_b32 v246, v246, v141, v143
    v_or3_b32 v246, v246, v145, v147
    v_cmp_ne_u32 vcc, 0, v246
    s_cbranch_vccz L_ok_7
    s_sleep 8
    s_sub_u32 s14, s14, 1
    s_cbranch_scc0 L_spin_6
L_ok_7:
    v_and_b32 v132, 0xffffff00, v132
    v_and_b32 v134, 0xffffff00, v134
    v_and_b32 v136, 0xffffff00, v136
    v_and_b32 v138, 0xffffff00, v138
    v_and_b32 v140, 0xffffff00, v140
    v_and_b32 v142, 0xffffff00, v142
    v_and_b32 v144, 0xffffff00, v144
    v_and_b32 v146, 0xffffff00, v146
    v_add_f32 v132, v132, v136
    v_add_f32 v134, v134, v138
    v_add_f32 v140, v140, v144
    v_add_f32 v142, v142, v146
    v_add_f32 v132, v132, v140
    v_add_f32 v134, v134, v142
    v_cvt_pk_bf16_f32 v132, v132, v134
    ds_write_b32 v249, v132 offset:40960
    buffer_load_dwordx4 v[68:71], v1, s[48:51], s5 offen offset:0 nt
    s_add_u32 s5, s5, 8192
    buffer_load_dwordx4 v[72:75], v1, s[48:51], s5 offen offset:0 nt
    s_add_u32 s5, s5, 8192
    buffer_load_dwordx4 v[76:79], v1, s[48:51], s5 offen offset:0 nt
    s_add_u32 s5, s5, 8192
    buffer_load_dwordx4 v[80:83], v1, s[48:51], s5 offen offset:0 nt
    s_add_u32 s5, s5, 8192
    s_branch L_skip_4
L_other_5:
    buffer_load_dwordx4 v[68:71], v1, s[48:51], s5 offen offset:0 nt
    s_add_u32 s5, s5, 8192
    buffer_load_dwordx4 v[72:75], v1, s[48:51], s5 offen offset:0 nt
    s_add_u32 s5, s5, 8192
    buffer_load_dwordx4 v[76:79], v1, s[48:51], s5 offen offset:0 nt
    s_add_u32 s5, s5, 8192
    buffer_load_dwordx4 v[80:83], v1, s[48:51], s5 offen offset:0 nt
    s_add_u32 s5, s5, 8192
L_skip_4:
    v_bfe_u32 v246, v0, 2, 1
    v_lshlrev_b32 v246, 8, v246
    v_and_b32 v248, 0xf0, v1
    v_add_u32 v247, v246, v248
    v_lshrrev_b32 v248, 4, v0
    v_lshl_add_u32 v246, v248, 3, v246
    s_lshl_b32 s11, s3, 5
    v_add_u32 v246, s11, v246
    s_waitcnt lgkmcnt(0)
    s_barrier
    ds_read_b128 v[10:13], v247 offset:40960
    s_waitcnt lgkmcnt(0)
    s_waitcnt vmcnt(12)
    v_mfma_f32_16x16x32_bf16 v[132:135], v[148:151], v[10:13], 0
    v_mfma_f32_16x16x32_bf16 v[136:139], v[152:155], v[10:13], 0
    v_mfma_f32_16x16x32_bf16 v[140:143], v[156:159], v[10:13], 0
    v_mfma_f32_16x16x32_bf16 v[144:147], v[160:163], v[10:13], 0
    s_nop 4
    v_mov_b32_dpp v132, v132 quad_perm:[0,0,0,0] row_mask:0xf bank_mask:0xf
    v_mov_b32_dpp v136, v136 quad_perm:[0,0,0,0] row_mask:0xf bank_mask:0xf
    v_mov_b32_dpp v140, v140 quad_perm:[0,0,0,0] row_mask:0xf bank_mask:0xf
    v_mov_b32_dpp v144, v144 quad_perm:[0,0,0,0] row_mask:0xf bank_mask:0xf
    v_add_f32_dpp v132, v133, v132 quad_perm:[1,1,1,1] row_mask:0xf bank_mask:0xf
    v_add_f32_dpp v136, v137, v136 quad_perm:[1,1,1,1] row_mask:0xf bank_mask:0xf
    v_add_f32_dpp v140, v141, v140 quad_perm:[1,1,1,1] row_mask:0xf bank_mask:0xf
    v_add_f32_dpp v144, v145, v144 quad_perm:[1,1,1,1] row_mask:0xf bank_mask:0xf
    v_add_f32_dpp v132, v134, v132 quad_perm:[2,2,2,2] row_mask:0xf bank_mask:0xf
    v_add_f32_dpp v136, v138, v136 quad_perm:[2,2,2,2] row_mask:0xf bank_mask:0xf
    v_add_f32_dpp v140, v142, v140 quad_perm:[2,2,2,2] row_mask:0xf bank_mask:0xf
    v_add_f32_dpp v144, v146, v144 quad_perm:[2,2,2,2] row_mask:0xf bank_mask:0xf
    v_add_f32_dpp v132, v135, v132 quad_perm:[3,3,3,3] row_mask:0xf bank_mask:0xf
    v_add_f32_dpp v136, v139, v136 quad_perm:[3,3,3,3] row_mask:0xf bank_mask:0xf
    v_add_f32_dpp v140, v143, v140 quad_perm:[3,3,3,3] row_mask:0xf bank_mask:0xf
    v_add_f32_dpp v144, v147, v144 quad_perm:[3,3,3,3] row_mask:0xf bank_mask:0xf
    v_cvt_pk_bf16_f32 v14, v132, v136
    v_cvt_pk_bf16_f32 v15, v140, v144
    s_mov_b32 exec_lo, 0x00110011
    s_mov_b32 exec_hi, 0x00110011
    ds_write_b64 v246, v[14:15] offset:41472
    s_mov_b64 exec, -1
    s_waitcnt lgkmcnt(0)
    s_barrier
    s_cmp_lg_u32 s3, 7
    s_cbranch_scc1 L_skip_8
    ds_read_b128 v[14:17], v2 offset:41472
    s_lshl_b32 s10, s2, 8
    s_add_u32 s10, s10, 131072
    s_waitcnt lgkmcnt(0)
    v_min_u32 v14, -2, v14
    v_min_u32 v15, -2, v15
    v_min_u32 v16, -2, v16
    v_min_u32 v17, -2, v17
    s_mov_b32 exec_hi, 0
    buffer_store_dwordx4 v[14:17], v22, s[44:47], s10 offen sc1
    s_mov_b64 exec, -1
L_skip_8:
    s_barrier
    s_cmp_eq_u32 s3, 0
    s_cselect_b32 s13, 0, 0x40000000
    s_lshl_b32 s12, s7, 7
    s_add_u32 s12, s12, 327680
    s_add_u32 s12, s12, s13
    v_lshlrev_b32 v26, 3, v0
    s_mov_b64 exec, 0xffff
    buffer_load_dwordx2 v[24:25], v26, s[44:47], s12 offen sc1
    s_mov_b64 exec, -1
    s_waitcnt vmcnt(12)
    s_waitcnt vmcnt(11)
    s_waitcnt vmcnt(10)
    s_waitcnt vmcnt(9)
    s_waitcnt vmcnt(8)
    s_waitcnt vmcnt(7)
    s_waitcnt vmcnt(6)
    s_waitcnt vmcnt(5)
    s_waitcnt vmcnt(4)
    buffer_load_dwordx4 v[84:87], v1, s[48:51], s5 offen offset:0 nt
    s_add_u32 s5, s5, 8192
    s_waitcnt vmcnt(4)
    buffer_load_dwordx4 v[88:91], v1, s[48:51], s5 offen offset:0 nt
    s_add_u32 s5, s5, 8192
    s_waitcnt vmcnt(4)
    buffer_load_dwordx4 v[92:95], v1, s[48:51], s5 offen offset:0 nt
    s_add_u32 s5, s5, 8192
    s_waitcnt vmcnt(4)
    buffer_load_dwordx4 v[96:99], v1, s[48:51], s5 offen offset:0 nt
    s_add_u32 s5, s5, 8192
    s_lshl_b32 s10, s8, 14
    s_lshl_b32 s11, s7, 11
    s_add_u32 s10, s10, s11
    s_add_u32 s10, s10, 0
    s_add_u32 s10, s10, s13
    s_add_u32 s11, s10, 32768
    v_lshlrev_b32 v3, 5, v0
    s_waitcnt vmcnt(4)
    s_cmp_lg_u32 s3, 0
    s_cbranch_scc1 L_ok_10
    s_mov_b64 exec, 0xffff
L_spin_9:
    v_cmp_ne_u64 vcc, s[94:95], v[24:25]
    s_cbranch_vccz L_ok_10
    buffer_load_dwordx2 v[24:25], v26, s[44:47], s12 offen sc1
    s_waitcnt vmcnt(0)
    s_sub_u32 s14, s14, 1
    s_cbranch_scc0 L_spin_9
L_ok_10:
    s_mov_b64 exec, -1
    buffer_load_dwordx4 v[228:231], v3, s[44:47], s10 offen offset:0 sc1
    buffer_load_dwordx4 v[232:235], v3, s[44:47], s10 offen offset:16 sc1
    buffer_load_dwordx4 v[236:239], v3, s[44:47], s11 offen offset:0 sc1
    buffer_load_dwordx4 v[240:243], v3, s[44:47], s11 offen offset:16 sc1
    s_waitcnt vmcnt(7)
    buffer_load_dwordx4 v[100:103], v1, s[48:51], s5 offen offset:0 nt
    s_add_u32 s5, s5, 8192
    s_waitcnt vmcnt(7)
    buffer_load_dwordx4 v[104:107], v1, s[48:51], s5 offen offset:0 nt
    s_add_u32 s5, s5, 8192
    s_waitcnt vmcnt(7)
    buffer_load_dwordx4 v[108:111], v1, s[48:51], s5 offen offset:0 nt
    s_add_u32 s5, s5, 8192
    s_waitcnt vmcnt(7)
    buffer_load_dwordx4 v[112:115], v1, s[48:51], s5 offen offset:0 nt
    s_add_u32 s5, s5, 8192
    s_cmp_lg_u32 s3, 0
    s_cbranch_scc1 L_skip_11
    s_waitcnt vmcnt(4)
    v_add_f32 v228, v228, v236
    v_add_f32 v229, v229, v237
    v_add_f32 v230, v230, v238
    v_add_f32 v231, v231, v239
    v_add_f32 v232, v232, v240
    v_add_f32 v233, v233, v241
    v_add_f32 v234, v234, v242
    v_add_f32 v235, v235, v243
    v_cvt_pk_bf16_f32 v228, v228, v229
    v_cvt_pk_bf16_f32 v229, v230, v231
    v_cvt_pk_bf16_f32 v230, v232, v233
    v_cvt_pk_bf16_f32 v231, v234, v235
    v_mov_b32 v24, 0
    v_mov_b32 v25, 1
    ds_write_b128 v2, v[228:231] offset:8192
    s_waitcnt lgkmcnt(0)
    ds_write_b32 v24, v25 offset:9472
L_skip_11:
    v_mov_b32 v24, 0
    s_mov_b32 s14, 400000
L_spin_12:
    ds_read_b32 v25, v24 offset:9472
    ds_read_b128 v[10:13], v1 offset:8192
    s_waitcnt lgkmcnt(0)
    v_cmp_eq_u32 vcc, 0, v25
    s_cbranch_vccz L_ok_13
    s_sleep 1
    s_sub_u32 s14, s14, 1
    s_cbranch_scc0 L_spin_12
L_ok_13:
    v_bfe_u32 v29, v0, 2, 2
    v_lshlrev_b32 v29, 5, v29
    s_lshl_b32 s10, s3, 2
    v_add_u32 v30, s10, v29
    v_mov_b32 v228, 0
    v_mov_b32 v229, 0
    v_mov_b32 v232, 0
    v_mov_b32 v233, 0
    v_mov_b32 v236, 0
    v_mov_b32 v237, 0
    v_mov_b32 v240, 0
    v_mov_b32 v241, 0
    v_mov_b32 v244, 0
    v_mov_b32 v245, 0
    buffer_load_dwordx4 v[116:119], v1, s[48:51], s5 offen offset:0 nt
    s_add_u32 s5, s5, 8192
    buffer_load_dwordx4 v[120:123], v1, s[48:51], s5 offen offset:0 nt
    s_add_u32 s5, s5, 8192
    v_mfma_f32_16x16x32_bf16 v[32:35], v[36:39], v[10:13], 0
    v_mfma_f32_16x16x32_bf16 v[36:39], v[40:43], v[10:13], 0
    v_mfma_f32_16x16x32_bf16 v[40:43], v[44:47], v[10:13], 0
    v_mfma_f32_16x16x32_bf16 v[44:47], v[48:51], v[10:13], 0
    buffer_load_dwordx4 v[124:127], v1, s[48:51], s5 offen offset:0 nt
    s_add_u32 s5, s5, 8192
    buffer_load_dwordx4 v[128:131], v1, s[48:51], s5 offen offset:0 nt
    v_mfma_f32_16x16x32_bf16 v[48:51], v[52:55], v[10:13], 0
    v_mfma_f32_16x16x32_bf16 v[52:55], v[56:59], v[10:13], 0
    v_mfma_f32_16x16x32_bf16 v[56:59], v[60:63], v[10:13], 0
    v_mfma_f32_16x16x32_bf16 v[60:63], v[64:67], v[10:13], 0
    v_mov_b32_dpp v32, v32 quad_perm:[0,0,0,0] row_mask:0xf bank_mask:0xf
    v_mov_b32_dpp v36, v36 quad_perm:[0,0,0,0] row_mask:0xf bank_mask:0xf
    v_mov_b32_dpp v40, v40 quad_perm:[0,0,0,0] row_mask:0xf bank_mask:0xf
    v_mov_b32_dpp v44, v44 quad_perm:[0,0,0,0] row_mask:0xf bank_mask:0xf
    v_add_f32_dpp v32, v33, v32 quad_perm:[1,1,1,1] row_mask:0xf bank_mask:0xf
    v_add_f32_dpp v36, v37, v36 quad_perm:[1,1,1,1] row_mask:0xf bank_mask:0xf
    v_add_f32_dpp v40, v41, v40 quad_perm:[1,1,1,1] row_mask:0xf bank_mask:0xf
    v_add_f32_dpp v44, v45, v44 quad_perm:[1,1,1,1] row_mask:0xf bank_mask:0xf
    v_add_f32_dpp v32, v34, v32 quad_perm:[2,2,2,2] row_mask:0xf bank_mask:0xf
    v_add_f32_dpp v36, v38, v36 quad_perm:[2,2,2,2] row_mask:0xf bank_mask:0xf
    v_add_f32_dpp v40, v42, v40 quad_perm:[2,2,2,2] row_mask:0xf bank_mask:0xf
    v_add_f32_dpp v44, v46, v44 quad_perm:[2,2,2,2] row_mask:0xf bank_mask:0xf
    v_add_f32_dpp v32, v35, v32 quad_perm:[3,3,3,3] row_mask:0xf bank_mask:0xf
    v_add_f32_dpp v36, v39, v36 quad_perm:[3,3,3,3] row_mask:0xf bank_mask:0xf
    v_add_f32_dpp v40, v43, v40 quad_perm:[3,3,3,3] row_mask:0xf bank_mask:0xf
    v_add_f32_dpp v44, v47, v44 quad_perm:[3,3,3,3] row_mask:0xf bank_mask:0xf
    v_max3_f32 v23, v32, v36, v40
    v_max_f32 v23, v23, v44
    buffer_load_dwordx4 v[132:135], v2, s[52:55], s6 offen offset:0 nt
    s_add_u32 s6, s6, 8192
    buffer_load_dwordx4 v[136:139], v2, s[52:55], s6 offen offset:0 nt
    s_add_u32 s6, s6, 8192
    v_mfma_f32_16x16x32_bf16 v[64:67], v[68:71], v[10:13], 0
    v_mfma_f32_16x16x32_bf16 v[68:71], v[72:75], v[10:13], 0
    v_mfma_f32_16x16x32_bf16 v[72:75], v[76:79], v[10:13], 0
    v_mfma_f32_16x16x32_bf16 v[76:79], v[80:83], v[10:13], 0
    v_mov_b32_dpp v48, v48 quad_perm:[0,0,0,0] row_mask:0xf bank_mask:0xf
    v_mov_b32_dpp v52, v52 quad_perm:[0,0,0,0] row_mask:0xf bank_mask:0xf
    v_mov_b32_dpp v56, v56 quad_perm:[0,0,0,0] row_mask:0xf bank_mask:0xf
    v_mov_b32_dpp v60, v60 quad_perm:[0,0,0,0] row_mask:0xf bank_mask:0xf
    v_add_f32_dpp v48, v49, v48 quad_perm:[1,1,1,1] row_mask:0xf bank_mask:0xf
    v_add_f32_dpp v52, v53, v52 quad_perm:[1,1,1,1] row_mask:0xf bank_mask:0xf
    v_add_f32_dpp v56, v57, v56 quad_perm:[1,1,1,1] row_mask:0xf bank_mask:0xf
    v_add_f32_dpp v60, v61, v60 quad_perm:[1,1,1,1] row_mask:0xf bank_mask:0xf
    v_add_f32_dpp v48, v50, v48 quad_perm:[2,2,2,2] row_mask:0xf bank_mask:0xf
    v_add_f32_dpp v52, v54, v52 quad_perm:[2,2,2,2] row_mask:0xf bank_mask:0xf
    v_add_f32_dpp v56, v58, v56 quad_perm:[2,2,2,2] row_mask:0xf bank_mask:0xf
    v_add_f32_dpp v60, v62, v60 quad_perm:[2,2,2,2] row_mask:0xf bank_mask:0xf
    v_add_f32_dpp v48, v51, v48 quad_perm:[3,3,3,3] row_mask:0xf bank_mask:0xf
    v_add_f32_dpp v52, v55, v52 quad_perm:[3,3,3,3] row_mask:0xf bank_mask:0xf
    v_add_f32_dpp v56, v59, v56 quad_perm:[3,3,3,3] row_mask:0xf bank_mask:0xf
    v_add_f32_dpp v60, v63, v60 quad_perm:[3,3,3,3] row_mask:0xf bank_mask:0xf
    v_max3_f32 v23, v23, v48, v52
    v_max3_f32 v23, v23, v56, v60
    buffer_load_dwordx4 v[140:143], v2, s[52:55], s6 offen offset:0 nt
    s_add_u32 s6, s6, 8192
    buffer_load_dwordx4 v[144:147], v2, s[52:55], s6 offen offset:0 nt
    s_add_u32 s6, s6, 8192
    v_mfma_f32_16x16x32_bf16 v[80:83], v[84:87], v[10:13], 0
    v_mfma_f32_16x16x32_bf16 v[84:87], v[88:91], v[10:13], 0
    v_mfma_f32_16x16x32_bf16 v[88:91], v[92:95], v[10:13], 0
    v_mfma_f32_16x16x32_bf16 v[92:95], v[96:99], v[10:13], 0
    v_mov_b32_dpp v64, v64 quad_perm:[0,0,0,0] row_mask:0xf bank_mask:0xf
    v_mov_b32_dpp v68, v68 quad_perm:[0,0,0,0] row_mask:0xf bank_mask:0xf
    v_mov_b32_dpp v72, v72 quad_perm:[0,0,0,0] row_mask:0xf bank_mask:0xf
    v_mov_b32_dpp v76, v76 quad_perm:[0,0,0,0] row_mask:0xf bank_mask:0xf
    v_add_f32_dpp v64, v65, v64 quad_perm:[1,1,1,1] row_mask:0xf bank_mask:0xf
    v_add_f32_dpp v68, v69, v68 quad_perm:[1,1,1,1] row_mask:0xf bank_mask:0xf
    v_add_f32_dpp v72, v73, v72 quad_perm:[1,1,1,1] row_mask:0xf bank_mask:0xf
    v_add_f32_dpp v76, v77, v76 quad_perm:[1,1,1,1] row_mask:0xf bank_mask:0xf
    v_add_f32_dpp v64, v66, v64 quad_perm:[2,2,2,2] row_mask:0xf bank_mask:0xf
    v_add_f32_dpp v68, v70, v68 quad_perm:[2,2,2,2] row_mask:0xf bank_mask:0xf
    v_add_f32_dpp v72, v74, v72 quad_perm:[2,2,2,2] row_mask:0xf bank_mask:0xf
    v_add_f32_dpp v76, v78, v76 quad_perm:[2,2,2,2] row_mask:0xf bank_mask:0xf
    v_add_f32_dpp v64, v67, v64 quad_perm:[3,3,3,3] row_mask:0xf bank_mask:0xf
    v_add_f32_dpp v68, v71, v68 quad_perm:[3,3,3,3] row_mask:0xf bank_mask:0xf
    v_add_f32_dpp v72, v75, v72 quad_perm:[3,3,3,3] row_mask:0xf bank_mask:0xf
    v_add_f32_dpp v76, v79, v76 quad_perm:[3,3,3,3] row_mask:0xf bank_mask:0xf
    v_max3_f32 v23, v23, v64, v68
    v_max3_f32 v23, v23, v72, v76
    s_waitcnt vmcnt(11)
    v_mfma_f32_16x16x32_bf16 v[96:99], v[100:103], v[10:13], 0
    s_waitcnt vmcnt(10)
    v_mfma_f32_16x16x32_bf16 v[100:103], v[104:107], v[10:13], 0
    s_waitcnt vmcnt(9)
    v_mfma_f32_16x16x32_bf16 v[104:107], v[108:111], v[10:13], 0
    s_waitcnt vmcnt(8)
    v_mfma_f32_16x16x32_bf16 v[108:111], v[112:115], v[10:13], 0
    v_mov_b32_dpp v80, v80 quad_perm:[0,0,0,0] row_mask:0xf bank_mask:0xf
    v_mov_b32_dpp v84, v84 quad_perm:[0,0,0,0] row_mask:0xf bank_mask:0xf
    v_mov_b32_dpp v88, v88 quad_perm:[0,0,0,0] row_mask:0xf bank_mask:0xf
    v_mov_b32_dpp v92, v92 quad_perm:[0,0,0,0] row_mask:0xf bank_mask:0xf
    v_add_f32_dpp v80, v81, v80 quad_perm:[1,1,1,1] row_mask:0xf bank_mask:0xf
    v_add_f32_dpp v84, v85, v84 quad_perm:[1,1,1,1] row_mask:0xf bank_mask:0xf
    v_add_f32_dpp v88, v89, v88 quad_perm:[1,1,1,1] row_mask:0xf bank_mask:0xf
    v_add_f32_dpp v92, v93, v92 quad_perm:[1,1,1,1] row_mask:0xf bank_mask:0xf
    v_add_f32_dpp v80, v82, v80 quad_perm:[2,2,2,2] row_mask:0xf bank_mask:0xf
    v_add_f32_dpp v84, v86, v84 quad_perm:[2,2,2,2] row_mask:0xf bank_mask:0xf
    v_add_f32_dpp v88, v90, v88 quad_perm:[2,2,2,2] row_mask:0xf bank_mask:0xf
    v_add_f32_dpp v92, v94, v92 quad_perm:[2,2,2,2] row_mask:0xf bank_mask:0xf
    v_add_f32_dpp v80, v83, v80 quad_perm:[3,3,3,3] row_mask:0xf bank_mask:0xf
    v_add_f32_dpp v84, v87, v84 quad_perm:[3,3,3,3] row_mask:0xf bank_mask:0xf
    v_add_f32_dpp v88, v91, v88 quad_perm:[3,3,3,3] row_mask:0xf bank_mask:0xf
    v_add_f32_dpp v92, v95, v92 quad_perm:[3,3,3,3] row_mask:0xf bank_mask:0xf
    v_max3_f32 v23, v23, v80, v84
    v_max3_f32 v23, v23, v88, v92
    s_waitcnt vmcnt(7)
    buffer_load_dwordx4 v[148:151], v2, s[52:55], s6 offen offset:0 nt
    s_add_u32 s6, s6, 8192
    v_mfma_f32_16x16x32_bf16 v[112:115], v[116:119], v[10:13], 0
    s_waitcnt vmcnt(7)
    buffer_load_dwordx4 v[152:155], v2, s[52:55], s6 offen offset:0 nt
    s_add_u32 s6, s6, 8192
    v_mfma_f32_16x16x32_bf16 v[116:119], v[120:123], v[10:13], 0
    s_waitcnt vmcnt(7)
    buffer_load_dwordx4 v[156:159], v2, s[52:55], s6 offen offset:0 nt
    s_add_u32 s6, s6, 8192
    v_mfma_f32_16x16x32_bf16 v[120:123], v[124:127], v[10:13], 0
    s_waitcnt vmcnt(7)
    buffer_load_dwordx4 v[160:163], v2, s[52:55], s6 offen offset:0 nt
    s_add_u32 s6, s6, 8192
    v_mfma_f32_16x16x32_bf16 v[124:127], v[128:131], v[10:13], 0
    v_mov_b32_dpp v96, v96 quad_perm:[0,0,0,0] row_mask:0xf bank_mask:0xf
    v_mov_b32_dpp v100, v100 quad_perm:[0,0,0,0] row_mask:0xf bank_mask:0xf
    v_mov_b32_dpp v104, v104 quad_perm:[0,0,0,0] row_mask:0xf bank_mask:0xf
    v_mov_b32_dpp v108, v108 quad_perm:[0,0,0,0] row_mask:0xf bank_mask:0xf
    v_add_f32_dpp v96, v97, v96 quad_perm:[1,1,1,1] row_mask:0xf bank_mask:0xf
    v_add_f32_dpp v100, v101, v100 quad_perm:[1,1,1,1] row_mask:0xf bank_mask:0xf
    v_add_f32_dpp v104, v105, v104 quad_perm:[1,1,1,1] row_mask:0xf bank_mask:0xf
    v_add_f32_dpp v108, v109, v108 quad_perm:[1,1,1,1] row_mask:0xf bank_mask:0xf
    v_add_f32_dpp v96, v98, v96 quad_perm:[2,2,2,2] row_mask:0xf bank_mask:0xf
    v_add_f32_dpp v100, v102, v100 quad_perm:[2,2,2,2] row_mask:0xf bank_mask:0xf
    v_add_f32_dpp v104, v106, v104 quad_perm:[2,2,2,2] row_mask:0xf bank_mask:0xf
    v_add_f32_dpp v108, v110, v108 quad_perm:[2,2,2,2] row_mask:0xf bank_mask:0xf
    v_add_f32_dpp v96, v99, v96 quad_perm:[3,3,3,3] row_mask:0xf bank_mask:0xf
    v_add_f32_dpp v100, v103, v100 quad_perm:[3,3,3,3] row_mask:0xf bank_mask:0xf
    v_add_f32_dpp v104, v107, v104 quad_perm:[3,3,3,3] row_mask:0xf bank_mask:0xf
    v_add_f32_dpp v108, v111, v108 quad_perm:[3,3,3,3] row_mask:0xf bank_mask:0xf
    v_max3_f32 v23, v23, v96, v100
    v_max3_f32 v23, v23, v104, v108
    v_mov_b32_dpp v112, v112 quad_perm:[0,0,0,0] row_mask:0xf bank_mask:0xf
    v_mov_b32_dpp v116, v116 quad_perm:[0,0,0,0] row_mask:0xf bank_mask:0xf
    v_mov_b32_dpp v120, v120 quad_perm:[0,0,0,0] row_mask:0xf bank_mask:0xf
    v_mov_b32_dpp v124, v124 quad_perm:[0,0,0,0] row_mask:0xf bank_mask:0xf
    v_add_f32_dpp v112, v113, v112 quad_perm:[1,1,1,1] row_mask:0xf bank_mask:0xf
    v_add_f32_dpp v116, v117, v116 quad_perm:[1,1,1,1] row_mask:0xf bank_mask:0xf
    v_add_f32_dpp v120, v121, v120 quad_perm:[1,1,1,1] row_mask:0xf bank_mask:0xf
    v_add_f32_dpp v124, v125, v124 quad_perm:[1,1,1,1] row_mask:0xf bank_mask:0xf
    v_add_f32_dpp v112, v114, v112 quad_perm:[2,2,2,2] row_mask:0xf bank_mask:0xf
    v_add_f32_dpp v116, v118, v116 quad_perm:[2,2,2,2] row_mask:0xf bank_mask:0xf
    v_add_f32_dpp v120, v122, v120 quad_perm:[2,2,2,2] row_mask:0xf bank_mask:0xf
    v_add_f32_dpp v124, v126, v124 quad_perm:[2,2,2,2] row_mask:0xf bank_mask:0xf
    v_add_f32_dpp v112, v115, v112 quad_perm:[3,3,3,3] row_mask:0xf bank_mask:0xf
    v_add_f32_dpp v116, v119, v116 quad_perm:[3,3,3,3] row_mask:0xf bank_mask:0xf
    v_add_f32_dpp v120, v123, v120 quad_perm:[3,3,3,3] row_mask:0xf bank_mask:0xf
    v_add_f32_dpp v124, v127, v124 quad_perm:[3,3,3,3] row_mask:0xf bank_mask:0xf
    v_max3_f32 v23, v23, v112, v116
    v_max3_f32 v23, v23, v120, v124
    v_mov_b32 v3, v23
    s_nop 1
    v_permlane16_swap_b32 v23, v3
    v_max_f32 v23, v23, v3
    v_mov_b32 v3, v23
    s_nop 1
    v_permlane32_swap_b32 v23, v3
    v_max_f32 v23, v23, v3
    v_mul_f32 v23, s15, v23
    ds_write_b32 v30, v23 offset:9216
    v_fma_f32 v32, v32, s15, -v23
    v_fma_f32 v36, v36, s15, -v23
    v_fma_f32 v40, v40, s15, -v23
    v_fma_f32 v44, v44, s15, -v23
    v_fma_f32 v48, v48, s15, -v23
    v_fma_f32 v52, v52, s15, -v23
    v_fma_f32 v56, v56, s15, -v23
    v_fma_f32 v60, v60, s15, -v23
    v_fma_f32 v64, v64, s15, -v23
    v_fma_f32 v68, v68, s15, -v23
    v_fma_f32 v72, v72, s15, -v23
    v_fma_f32 v76, v76, s15, -v23
    v_fma_f32 v80, v80, s15, -v23
    v_fma_f32 v84, v84, s15, -v23
    v_fma_f32 v88, v88, s15, -v23
    v_fma_f32 v92, v92, s15, -v23
    v_fma_f32 v96, v96, s15, -v23
    v_fma_f32 v100, v100, s15, -v23
    v_fma_f32 v104, v104, s15, -v23
    v_fma_f32 v108, v108, s15, -v23
    v_fma_f32 v112, v112, s15, -v23
    v_fma_f32 v116, v116, s15, -v23
    v_fma_f32 v120, v120, s15, -v23
    v_fma_f32 v124, v124, s15, -v23
    v_exp_f32 v32, v32
    v_exp_f32 v36, v36
    v_exp_f32 v40, v40
    v_exp_f32 v44, v44
    v_exp_f32 v48, v48
    v_exp_f32 v52, v52
    v_exp_f32 v56, v56
    v_exp_f32 v60, v60
    v_exp_f32 v64, v64
    v_exp_f32 v68, v68
    v_exp_f32 v72, v72
    v_exp_f32 v76, v76
    v_exp_f32 v80, v80
    v_exp_f32 v84, v84
    v_exp_f32 v88, v88
    v_exp_f32 v92, v92
    v_exp_f32 v96, v96
    v_exp_f32 v100, v100
    v_exp_f32 v104, v104
    v_exp_f32 v108, v108
    v_exp_f32 v112, v112
    v_exp_f32 v116, v116
    v_exp_f32 v120, v120
    v_exp_f32 v124, v124
    v_add_f32 v22, v32, v36
    v_add_f32 v22, v22, v40
    v_add_f32 v22, v22, v44
    v_add_f32 v22, v22, v48
    v_add_f32 v22, v22, v52
    v_add_f32 v22, v22, v56
    v_add_f32 v22, v22, v60
    v_add_f32 v22, v22, v64
    v_add_f32 v22, v22, v68
    v_add_f32 v22, v22, v72
    v_add_f32 v22, v22, v76
    v_add_f32 v22, v22, v80
    v_add_f32 v22, v22, v84
    v_add_f32 v22, v22, v88
    v_add_f32 v22, v22, v92
    v_add_f32 v22, v22, v96
    v_add_f32 v22, v22, v100
    v_add_f32 v22, v22, v104
    v_add_f32 v22, v22, v108
    v_add_f32 v22, v22, v112
    v_add_f32 v22, v22, v116
    v_add_f32 v22, v22, v120
    v_add_f32 v22, v22, v124
    v_cvt_pk_bf16_f32 v32, v32, v36
    v_cvt_pk_bf16_f32 v40, v40, v44
    v_cvt_pk_bf16_f32 v48, v48, v52
    v_cvt_pk_bf16_f32 v56, v56, v60
    v_cvt_pk_bf16_f32 v64, v64, v68
    v_cvt_pk_bf16_f32 v72, v72, v76
    v_cvt_pk_bf16_f32 v80, v80, v84
    v_cvt_pk_bf16_f32 v88, v88, v92
    v_cvt_pk_bf16_f32 v96, v96, v100
    v_cvt_pk_bf16_f32 v104, v104, v108
    v_cvt_pk_bf16_f32 v112, v112, v116
    v_cvt_pk_bf16_f32 v120, v120, v124
    v_mov_b32 v3, v22
    s_nop 1
    v_permlane16_swap_b32 v22, v3
    v_add_f32 v22, v22, v3
    v_mov_b32 v3, v22
    s_nop 1
    v_permlane32_swap_b32 v22, v3
    v_add_f32 v22, v22, v3
    ds_write_b32 v30, v22 offset:9344
    v_mov_b32 v24, 0
    v_mov_b32 v25, 1
    s_mov_b64 exec, 1
    ds_add_rtn_u32 v26, v24, v25 offset:9476
    s_waitcnt lgkmcnt(0)
    v_cmp_eq_u32 vcc, 7, v26
    s_mov_b64 exec, -1
    s_cbranch_vccz L_skip_14
    v_and_b32 v24, 3, v0
    v_lshlrev_b32 v24, 5, v24
    ds_read_b128 v[246:249], v24 offset:9216
    ds_read_b128 v[250:253], v24 offset:9232
    ds_read_b128 v[10:13], v24 offset:9344
    ds_read_b128 v[14:17], v24 offset:9360
    v_mov_b32 v27, s95
    s_lshl_b32 s10, s8, 3
    s_add_u32 s10, s10, s7
    s_mul_i32 s10, s10, 12
    s_add_u32 s10, s10, s9
    s_lshl_b32 s10, s10, 6
    s_add_u32 s10, s10, 294912
    s_mov_b32 s11, 0xffffff00
    s_waitcnt lgkmcnt(0)
    v_max3_f32 v26, v246, v247, v248
    v_max3_f32 v26, v26, v249, v250
    v_max3_f32 v26, v26, v251, v252
    v_max_f32 v26, v26, v253
    v_sub_f32 v246, v246, v26
    v_sub_f32 v247, v247, v26
    v_sub_f32 v248, v248, v26
    v_sub_f32 v249, v249, v26
    v_sub_f32 v250, v250, v26
    v_sub_f32 v251, v251, v26
    v_sub_f32 v252, v252, v26
    v_sub_f32 v253, v253, v26
    v_exp_f32 v246, v246
    v_exp_f32 v247, v247
    v_exp_f32 v248, v248
    v_exp_f32 v249, v249
    v_exp_f32 v250, v250
    v_exp_f32 v251, v251
    v_exp_f32 v252, v252
    v_exp_f32 v253, v253
    v_mul_f32 v25, v246, v10
    v_fmac_f32 v25, v247, v11
    v_fmac_f32 v25, v248, v12
    v_fmac_f32 v25, v249, v13
    v_fmac_f32 v25, v250, v14
    v_fmac_f32 v25, v251, v15
    v_fmac_f32 v25, v252, v16
    v_fmac_f32 v25, v253, v17
    v_bfi_b32 v248, s11, v25, v27
    v_bfi_b32 v246, s11, v26, v27
    v_mov_b32 v247, s94
    v_mov_b32 v249, s94
    s_mov_b64 exec, 15
    buffer_store_dwordx4 v[246:249], v2, s[44:47], s10 offen sc1
    s_mov_b64 exec, -1
L_skip_14:
    v_perm_b32 v230, v32, v32, v4
    v_perm_b32 v231, v32, v32, v5
    v_perm_b32 v234, v32, v32, v6
    v_perm_b32 v235, v32, v32, v7
    v_perm_b32 v238, v40, v40, v4
    v_perm_b32 v239, v40, v40, v5
    v_perm_b32 v242, v40, v40, v6
    v_perm_b32 v243, v40, v40, v7
    s_waitcnt vmcnt(7)
    v_mfma_f32_16x16x32_bf16 v[14:17], v[230:233], v[132:135], 0
    v_mfma_f32_16x16x32_bf16 v[18:21], v[228:231], v[132:135], 0
    s_waitcnt vmcnt(6)
    v_mfma_f32_16x16x32_bf16 v[14:17], v[234:237], v[136:139], v[14:17]
    v_mfma_f32_16x16x32_bf16 v[18:21], v[232:235], v[136:139], v[18:21]
    s_waitcnt vmcnt(5)
    v_mfma_f32_16x16x32_bf16 v[14:17], v[238:241], v[140:143], v[14:17]
    v_mfma_f32_16x16x32_bf16 v[18:21], v[236:239], v[140:143], v[18:21]
    s_waitcnt vmcnt(4)
    v_mfma_f32_16x16x32_bf16 v[14:17], v[242:245], v[144:147], v[14:17]
    v_mfma_f32_16x16x32_bf16 v[18:21], v[240:243], v[144:147], v[18:21]
    v_perm_b32 v230, v48, v48, v4
    v_perm_b32 v231, v48, v48, v5
    v_perm_b32 v234, v48, v48, v6
    v_perm_b32 v235, v48, v48, v7
    v_perm_b32 v238, v56, v56, v4
    v_perm_b32 v239, v56, v56, v5
    v_perm_b32 v242, v56, v56, v6
    v_perm_b32 v243, v56, v56, v7
    s_waitcnt vmcnt(3)
    buffer_load_dwordx4 v[164:167], v2, s[52:55], s6 offen offset:0 nt
    s_add_u32 s6, s6, 8192
    v_mfma_f32_16x16x32_bf16 v[14:17], v[230:233], v[148:151], v[14:17]
    v_mfma_f32_16x16x32_bf16 v[18:21], v[228:231], v[148:151], v[18:21]
    s_waitcnt vmcnt(3)
    buffer_load_dwordx4 v[168:171], v2, s[52:55], s6 offen offset:0 nt
    s_add_u32 s6, s6, 8192
    v_mfma_f32_16x16x32_bf16 v[14:17], v[234:237], v[152:155], v[14:17]
    v_mfma_f32_16x16x32_bf16 v[18:21], v[232:235], v[152:155], v[18:21]
    s_waitcnt vmcnt(3)
    buffer_load_dwordx4 v[172:175], v2, s[52:55], s6 offen offset:0 nt
    s_add_u32 s6, s6, 8192
    v_mfma_f32_16x16x32_bf16 v[14:17], v[238:241], v[156:159], v[14:17]
    v_mfma_f32_16x16x32_bf16 v[18:21], v[236:239], v[156:159], v[18:21]
    s_waitcnt vmcnt(3)
    buffer_load_dwordx4 v[176:179], v2, s[52:55], s6 offen offset:0 nt
    s_add_u32 s6, s6, 8192
    v_mfma_f32_16x16x32_bf16 v[14:17], v[242:245], v[160:163], v[14:17]
    v_mfma_f32_16x16x32_bf16 v[18:21], v[240:243], v[160:163], v[18:21]
    v_perm_b32 v230, v64, v64, v4
    v_perm_b32 v231, v64, v64, v5
    v_perm_b32 v234, v64, v64, v6
    v_perm_b32 v235, v64, v64, v7
    v_perm_b32 v238, v72, v72, v4
    v_perm_b32 v239, v72, v72, v5
    v_perm_b32 v242, v72, v72, v6
    v_perm_b32 v243, v72, v72, v7
    s_waitcnt vmcnt(3)
    buffer_load_dwordx4 v[180:183], v2, s[52:55], s6 offen offset:0 nt
    s_add_u32 s6, s6, 8192
    v_mfma_f32_16x16x32_bf16 v[14:17], v[230:233], v[164:167], v[14:17]
    v_mfma_f32_16x16x32_bf16 v[18:21], v[228:231], v[164:167], v[18:21]
    s_waitcnt vmcnt(3)
    buffer_load_dwordx4 v[184:187], v2, s[52:55], s6 offen offset:0 nt
    s_add_u32 s6, s6, 8192
    v_mfma_f32_16x16x32_bf16 v[14:17], v[234:237], v[168:171], v[14:17]
    v_mfma_f32_16x16x32_bf16 v[18:21], v[232:235], v[168:171], v[18:21]
    s_waitcnt vmcnt(3)
    buffer_load_dwordx4 v[188:191], v2, s[52:55], s6 offen offset:0 nt
    s_add_u32 s6, s6, 8192
    v_mfma_f32_16x16x32_bf16 v[14:17], v[238:241], v[172:175], v[14:17]
    v_mfma_f32_16x16x32_bf16 v[18:21], v[236:239], v[172:175], v[18:21]
    s_waitcnt vmcnt(3)
    buffer_load_dwordx4 v[192:195], v2, s[52:55], s6 offen offset:0 nt
    s_add_u32 s6, s6, 8192
    v_mfma_f32_16x16x32_bf16 v[14:17], v[242:245], v[176:179], v[14:17]
    v_mfma_f32_16x16x32_bf16 v[18:21], v[240:243], v[176:179], v[18:21]
    v_perm_b32 v230, v80, v80, v4
    v_perm_b32 v231, v80, v80, v5
    v_perm_b32 v234, v80, v80, v6
    v_perm_b32 v235, v80, v80, v7
    v_perm_b32 v238, v88, v88, v4
    v_perm_b32 v239, v88, v88, v5
    v_perm_b32 v242, v88, v88, v6
    v_perm_b32 v243, v88, v88, v7
    s_waitcnt vmcnt(3)
    buffer_load_dwordx4 v[196:199], v2, s[52:55], s6 offen offset:0 nt
    s_add_u32 s6, s6, 8192
    v_mfma_f32_16x16x32_bf16 v[14:17], v[230:233], v[180:183], v[14:17]
    v_mfma_f32_16x16x32_bf16 v[18:21], v[228:231], v[180:183], v[18:21]
    s_waitcnt vmcnt(3)
    buffer_load_dwordx4 v[200:203], v2, s[52:55], s6 offen offset:0 nt
    s_add_u32 s6, s6, 8192
    v_mfma_f32_16x16x32_bf16 v[14:17], v[234:237], v[184:187], v[14:17]
    v_mfma_f32_16x16x32_bf16 v[18:21], v[232:235], v[184:187], v[18:21]
    s_waitcnt vmcnt(3)
    buffer_load_dwordx4 v[204:207], v2, s[52:55], s6 offen offset:0 nt
    s_add_u32 s6, s6, 8192
    v_mfma_f32_16x16x32_bf16 v[14:17], v[238:241], v[188:191], v[14:17]
    v_mfma_f32_16x16x32_bf16 v[18:21], v[236:239], v[188:191], v[18:21]
    s_waitcnt vmcnt(3)
    buffer_load_dwordx4 v[208:211], v2, s[52:55], s6 offen offset:0 nt
    s_add_u32 s6, s6, 8192
    v_mfma_f32_16x16x32_bf16 v[14:17], v[242:245], v[192:195], v[14:17]
    v_mfma_f32_16x16x32_bf16 v[18:21], v[240:243], v[192:195], v[18:21]
    v_perm_b32 v230, v96, v96, v4
    v_perm_b32 v231, v96, v96, v5
    v_perm_b32 v234, v96, v96, v6
    v_perm_b32 v235, v96, v96, v7
    v_perm_b32 v238, v104, v104, v4
    v_perm_b32 v239, v104, v104, v5
    v_perm_b32 v242, v104, v104, v6
    v_perm_b32 v243, v104, v104, v7
    s_waitcnt vmcnt(3)
    buffer_load_dwordx4 v[212:215], v2, s[52:55], s6 offen offset:0 nt
    s_add_u32 s6, s6, 8192
    v_mfma_f32_16x16x32_bf16 v[14:17], v[230:233], v[196:199], v[14:17]
    v_mfma_f32_16x16x32_bf16 v[18:21], v[228:231], v[196:199], v[18:21]
    s_waitcnt vmcnt(3)
    buffer_load_dwordx4 v[216:219], v2, s[52:55], s6 offen offset:0 nt
    s_add_u32 s6, s6, 8192
    v_mfma_f32_16x16x32_bf16 v[14:17], v[234:237], v[200:203], v[14:17]
    v_mfma_f32_16x16x32_bf16 v[18:21], v[232:235], v[200:203], v[18:21]
    s_waitcnt vmcnt(3)
    buffer_load_dwordx4 v[220:223], v2, s[52:55], s6 offen offset:0 nt
    s_add_u32 s6, s6, 8192
    v_mfma_f32_16x16x32_bf16 v[14:17], v[238:241], v[204:207], v[14:17]
    v_mfma_f32_16x16x32_bf16 v[18:21], v[236:239], v[204:207], v[18:21]
    s_waitcnt vmcnt(3)
    buffer_load_dwordx4 v[224:227], v2, s[52:55], s6 offen offset:0 nt
    v_mfma_f32_16x16x32_bf16 v[14:17], v[242:245], v[208:211], v[14:17]
    v_mfma_f32_16x16x32_bf16 v[18:21], v[240:243], v[208:211], v[18:21]
    v_perm_b32 v230, v112, v112, v4
    v_perm_b32 v231, v112, v112, v5
    v_perm_b32 v234, v112, v112, v6
    v_perm_b32 v235, v112, v112, v7
    v_perm_b32 v238, v120, v120, v4
    v_perm_b32 v239, v120, v120, v5
    v_perm_b32 v242, v120, v120, v6
    v_perm_b32 v243, v120, v120, v7
    v_mov_b32 v24, 0
    v_lshrrev_b32 v25, 4, v0
    v_lshlrev_b32 v25, 5, v25
    s_lshl_b32 s10, s3, 2
    v_add_u32 v26, s10, v25
L_spin_15:
    ds_read_b32 v27, v24 offset:9476
    ds_read_b128 v[246:249], v25 offset:9216
    ds_read_b128 v[250:253], v25 offset:9232
    ds_read_b32 v22, v26 offset:9216
    s_waitcnt lgkmcnt(0)
    v_cmp_ne_u32 vcc, 8, v27
    s_cbranch_vccz L_ok_16
    s_sleep 1
    s_sub_u32 s14, s14, 1
    s_cbranch_scc0 L_spin_15
L_ok_16:
    v_max3_f32 v23, v246, v247, v248
    v_max3_f32 v23, v23, v249, v250
    v_max3_f32 v23, v23, v251, v252
    v_max_f32 v23, v23, v253
    v_sub_f32 v22, v22, v23
    v_exp_f32 v22, v22
    s_lshl_b32 s10, s3, 11
    v_lshl_add_u32 v24, v0, 5, s10
    s_lshl_b32 s10, s3, 8
    v_and_b32 v26, 31, v0
    v_lshl_add_u32 v25, v26, 3, s10
    v_lshlrev_b32 v26, 2, v0
    s_lshl_b32 s10, s7, 2
    s_lshr_b32 s11, s3, 1
    s_add_u32 s10, s10, s11
    s_lshl_b32 s10, s10, 15
    s_mul_i32 s11, s8, 24
    s_add_u32 s11, s11, s9
    s_add_u32 s11, s11, s9
    s_and_b32 s12, s3, 1
    s_add_u32 s11, s11, s12
    s_lshl_b32 s11, s11, 7
    s_add_u32 s10, s10, s11
    s_add_u32 s10, s10, 1048576
    s_waitcnt vmcnt(3)
    v_mfma_f32_16x16x32_bf16 v[14:17], v[230:233], v[212:215], v[14:17]
    v_mfma_f32_16x16x32_bf16 v[18:21], v[228:231], v[212:215], v[18:21]
    s_waitcnt vmcnt(2)
    v_mfma_f32_16x16x32_bf16 v[14:17], v[234:237], v[216:219], v[14:17]
    v_mfma_f32_16x16x32_bf16 v[18:21], v[232:235], v[216:219], v[18:21]
    s_waitcnt vmcnt(1)
    v_mfma_f32_16x16x32_bf16 v[14:17], v[238:241], v[220:223], v[14:17]
    v_mfma_f32_16x16x32_bf16 v[18:21], v[236:239], v[220:223], v[18:21]
    s_waitcnt vmcnt(0)
    v_mfma_f32_16x16x32_bf16 v[14:17], v[242:245], v[224:227], v[14:17]
    v_mfma_f32_16x16x32_bf16 v[18:21], v[240:243], v[224:227], v[18:21]
    s_nop 6
    v_mul_f32 v14, v14, v22
    v_mul_f32 v15, v15, v22
    v_mul_f32 v16, v16, v22
    v_mul_f32 v17, v17, v22
    v_mul_f32 v18, v18, v22
    v_mul_f32 v19, v19, v22
    v_mul_f32 v20, v20, v22
    v_mul_f32 v21, v21, v22
    ds_write_b128 v24, v[14:17] offset:16384
    ds_write_b128 v24, v[18:21] offset:16400
    s_waitcnt lgkmcnt(0)
    s_barrier
    ds_read_b64 v[36:37], v25 offset:16384
    ds_read_b64 v[38:39], v25 offset:18432
    ds_read_b64 v[40:41], v25 offset:20480
    ds_read_b64 v[42:43], v25 offset:22528
    ds_read_b64 v[44:45], v25 offset:24576
    ds_read_b64 v[46:47], v25 offset:26624
    ds_read_b64 v[48:49], v25 offset:28672
    ds_read_b64 v[50:51], v25 offset:30720
    s_waitcnt lgkmcnt(6)
    v_add_f32 v36, v36, v38
    v_add_f32 v37, v37, v39
    s_waitcnt lgkmcnt(4)
    v_add_f32 v40, v40, v42
    v_add_f32 v41, v41, v43
    v_add_f32 v36, v36, v40
    v_add_f32 v37, v37, v41
    s_waitcnt lgkmcnt(2)
    v_add_f32 v44, v44, v46
    v_add_f32 v45, v45, v47
    v_add_f32 v36, v36, v44
    v_add_f32 v37, v37, v45
    s_waitcnt lgkmcnt(0)
    v_add_f32 v48, v48, v50
    v_add_f32 v49, v49, v51
    v_add_f32 v36, v36, v48
    v_add_f32 v37, v37, v49
    v_cvt_pk_bf16_f32 v36, v36, v37
    v_min_u32 v36, -2, v36
    s_mov_b32 exec_hi, 0
    buffer_store_dword v36, v26, s[44:47], s10 offen sc1
    s_endpgm
L_L_REST:
    s_mov_b32 m0, s67
    s_nop 0
    buffer_load_dwordx4 v232, s[48:51], s66 offen offset:0 nt lds
    buffer_load_dwordx4 v233, s[48:51], s66 offen offset:1024 nt lds
    buffer_load_dwordx4 v234, s[48:51], s66 offen offset:2048 nt lds
    buffer_load_dwordx4 v235, s[48:51], s66 offen offset:3072 nt lds
    s_add_u32 s66, s66, 4096
    s_add_u32 s67, s67, 4096
    s_mov_b32 m0, s67
    s_nop 0
    buffer_load_dwordx4 v236, s[48:51], s66 offen offset:0 nt lds
    buffer_load_dwordx4 v237, s[48:51], s66 offen offset:1024 nt lds
    buffer_load_dwordx4 v238, s[48:51], s66 offen offset:2048 nt lds
    buffer_load_dwordx4 v239, s[48:51], s66 offen offset:3072 nt lds
    s_add_u32 s66, s66, 28672
    s_add_u32 s67, s67, 0x7000
    s_mov_b32 m0, s67
    s_nop 0
    buffer_load_dwordx4 v232, s[48:51], s66 offen offset:0 nt lds
    buffer_load_dwordx4 v233, s[48:51], s66 offen offset:1024 nt lds
    buffer_load_dwordx4 v234, s[48:51], s66 offen offset:2048 nt lds
    buffer_load_dwordx4 v235, s[48:51], s66 offen offset:3072 nt lds
    s_add_u32 s66, s66, 4096
    s_add_u32 s67, s67, 4096
    s_mov_b32 m0, s67
    s_nop 0
    buffer_load_dwordx4 v236, s[48:51], s66 offen offset:0 nt lds
    buffer_load_dwordx4 v237, s[48:51], s66 offen offset:1024 nt lds
    buffer_load_dwordx4 v238, s[48:51], s66 offen offset:2048 nt lds
    buffer_load_dwordx4 v239, s[48:51], s66 offen offset:3072 nt lds
    s_add_u32 s66, s66, 28672
    s_add_u32 s67, s67, 0x7000
    v_and_b32 v10, 3, v0
    v_lshlrev_b32 v10, 2, v10
    v_bfe_u32 v11, v0, 2, 2
    v_or_b32 v10, v10, v11
    v_lshrrev_b32 v11, 5, v0
    v_xor_b32 v10, v10, v11
    v_lshlrev_b32 v10, 4, v10
    v_and_b32 v11, 31, v0
    v_lshl_add_u32 v5, v11, 10, v10
    v_add_u32 v4, 131072, v5
    s_lshl_b32 s10, s5, 15
    v_add_u32 v5, s10, v5
    s_mov_b32 s15, 0x3e0293ee
    s_waitcnt vmcnt(16)
    s_barrier
    s_mov_b32 m0, s67
    s_nop 0
    buffer_load_dwordx4 v232, s[48:51], s66 offen offset:0 nt lds
    buffer_load_dwordx4 v233, s[48:51], s66 offen offset:1024 nt lds
    buffer_load_dwordx4 v234, s[48:51], s66 offen offset:2048 nt lds
    buffer_load_dwordx4 v235, s[48:51], s66 offen offset:3072 nt lds
    s_add_u32 s66, s66, 4096
    s_add_u32 s67, s67, 4096
    s_mov_b32 m0, s67
    s_nop 0
    buffer_load_dwordx4 v236, s[48:51], s66 offen offset:0 nt lds
    buffer_load_dwordx4 v237, s[48:51], s66 offen offset:1024 nt lds
    buffer_load_dwordx4 v238, s[48:51], s66 offen offset:2048 nt lds
    buffer_load_dwordx4 v239, s[48:51], s66 offen offset:3072 nt lds
    s_add_u32 s66, s66, 28672
    s_add_u32 s67, s67, 0xfffe7000
    s_cmp_lg_u32 s3, 4
    s_cbranch_scc1 L_skip_17
    v_xor_b32 v6, 0, v5
    ds_read_b128 v[32:35], v6 offset:0
    ds_read_b128 v[64:67], v6 offset:256
    ds_read_b128 v[160:163], v6 offset:512
    ds_read_b128 v[192:195], v6 offset:768
    v_xor_b32 v7, 32, v5
    ds_read_b128 v[36:39], v7 offset:0
    ds_read_b128 v[68:71], v7 offset:256
    ds_read_b128 v[164:167], v7 offset:512
    ds_read_b128 v[196:199], v7 offset:768
    s_waitcnt lgkmcnt(4)
    v_xor_b32 v6, 64, v5
    ds_read_b128 v[40:43], v6 offset:0
    ds_read_b128 v[72:75], v6 offset:256
    ds_read_b128 v[168:171], v6 offset:512
    ds_read_b128 v[200:203], v6 offset:768
    v_xor_b32 v7, 96, v5
    ds_read_b128 v[44:47], v7 offset:0
    ds_read_b128 v[76:79], v7 offset:256
    ds_read_b128 v[172:175], v7 offset:512
    ds_read_b128 v[204:207], v7 offset:768
    s_waitcnt lgkmcnt(4)
    v_xor_b32 v6, 128, v5
    ds_read_b128 v[48:51], v6 offset:0
    ds_read_b128 v[80:83], v6 offset:256
    ds_read_b128 v[176:179], v6 offset:512
    ds_read_b128 v[208:211], v6 offset:768
    v_xor_b32 v7, 160, v5
    ds_read_b128 v[52:55], v7 offset:0
    ds_read_b128 v[84:87], v7 offset:256
    ds_read_b128 v[180:183], v7 offset:512
    ds_read_b128 v[212:215], v7 offset:768
    s_waitcnt lgkmcnt(4)
    v_xor_b32 v6, 192, v5
    ds_read_b128 v[56:59], v6 offset:0
    ds_read_b128 v[88:91], v6 offset:256
    ds_read_b128 v[184:187], v6 offset:512
    ds_read_b128 v[216:219], v6 offset:768
    v_xor_b32 v7, 224, v5
    ds_read_b128 v[60:63], v7 offset:0
    ds_read_b128 v[92:95], v7 offset:256
    ds_read_b128 v[188:191], v7 offset:512
    ds_read_b128 v[220:223], v7 offset:768
    s_waitcnt lgkmcnt(4)
    s_waitcnt lgkmcnt(0)
L_skip_17:
    s_waitcnt vmcnt(16)
    s_barrier
    s_mov_b32 m0, s67
    s_nop 0
    buffer_load_dwordx4 v232, s[48:51], s66 offen offset:0 nt lds
    buffer_load_dwordx4 v233, s[48:51], s66 offen offset:1024 nt lds
    buffer_load_dwordx4 v234, s[48:51], s66 offen offset:2048 nt lds
    buffer_load_dwordx4 v235, s[48:51], s66 offen offset:3072 nt lds
    s_add_u32 s66, s66, 4096
    s_add_u32 s67, s67, 4096
    s_mov_b32 m0, s67
    s_nop 0
    buffer_load_dwordx4 v236, s[48:51], s66 offen offset:0 nt lds
    buffer_load_dwordx4 v237, s[48:51], s66 offen offset:1024 nt lds
    buffer_load_dwordx4 v238, s[48:51], s66 offen offset:2048 nt lds
    buffer_load_dwordx4 v239, s[48:51], s66 offen offset:3072 nt lds
    s_add_u32 s66, s66, 28672
    s_add_u32 s67, s67, 0x7000
    s_cmp_lg_u32 s3, 5
    s_cbranch_scc1 L_skip_18
    v_xor_b32 v6, 0, v5
    ds_read_b128 v[32:35], v6 offset:0
    ds_read_b128 v[64:67], v6 offset:256
    ds_read_b128 v[160:163], v6 offset:512
    ds_read_b128 v[192:195], v6 offset:768
    v_xor_b32 v7, 32, v5
    ds_read_b128 v[36:39], v7 offset:0
    ds_read_b128 v[68:71], v7 offset:256
    ds_read_b128 v[164:167], v7 offset:512
    ds_read_b128 v[196:199], v7 offset:768
    s_waitcnt lgkmcnt(4)
    v_xor_b32 v6, 64, v5
    ds_read_b128 v[40:43], v6 offset:0
    ds_read_b128 v[72:75], v6 offset:256
    ds_read_b128 v[168:171], v6 offset:512
    ds_read_b128 v[200:203], v6 offset:768
    v_xor_b32 v7, 96, v5
    ds_read_b128 v[44:47], v7 offset:0
    ds_read_b128 v[76:79], v7 offset:256
    ds_read_b128 v[172:175], v7 offset:512
    ds_read_b128 v[204:207], v7 offset:768
    s_waitcnt lgkmcnt(4)
    v_xor_b32 v6, 128, v5
    ds_read_b128 v[48:51], v6 offset:0
    ds_read_b128 v[80:83], v6 offset:256
    ds_read_b128 v[176:179], v6 offset:512
    ds_read_b128 v[208:211], v6 offset:768
    v_xor_b32 v7, 160, v5
    ds_read_b128 v[52:55], v7 offset:0
    ds_read_b128 v[84:87], v7 offset:256
    ds_read_b128 v[180:183], v7 offset:512
    ds_read_b128 v[212:215], v7 offset:768
    s_waitcnt lgkmcnt(4)
    v_xor_b32 v6, 192, v5
    ds_read_b128 v[56:59], v6 offset:0
    ds_read_b128 v[88:91], v6 offset:256
    ds_read_b128 v[184:187], v6 offset:512
    ds_read_b128 v[216:219], v6 offset:768
    v_xor_b32 v7, 224, v5
    ds_read_b128 v[60:63], v7 offset:0
    ds_read_b128 v[92:95], v7 offset:256
    ds_read_b128 v[188:191], v7 offset:512
    ds_read_b128 v[220:223], v7 offset:768
    s_waitcnt lgkmcnt(4)
    s_waitcnt lgkmcnt(0)
L_skip_18:
    s_waitcnt vmcnt(16)
    s_barrier
    s_mov_b32 m0, s67
    s_nop 0
    buffer_load_dwordx4 v232, s[48:51], s66 offen offset:0 nt lds
    buffer_load_dwordx4 v233, s[48:51], s66 offen offset:1024 nt lds
    buffer_load_dwordx4 v234, s[48:51], s66 offen offset:2048 nt lds
    buffer_load_dwordx4 v235, s[48:51], s66 offen offset:3072 nt lds
    s_add_u32 s66, s66, 4096
    s_add_u32 s67, s67, 4096
    s_mov_b32 m0, s67
    s_nop 0
    buffer_load_dwordx4 v236, s[48:51], s66 offen offset:0 nt lds
    buffer_load_dwordx4 v237, s[48:51], s66 offen offset:1024 nt lds
    buffer_load_dwordx4 v238, s[48:51], s66 offen offset:2048 nt lds
    buffer_load_dwordx4 v239, s[48:51], s66 offen offset:3072 nt lds
    s_add_u32 s66, s66, 28672
    s_add_u32 s67, s67, 0x7000
    s_cmp_lg_u32 s3, 6
    s_cbranch_scc1 L_skip_19
    v_xor_b32 v6, 0, v5
    ds_read_b128 v[32:35], v6 offset:0
    ds_read_b128 v[64:67], v6 offset:256
    ds_read_b128 v[160:163], v6 offset:512
    ds_read_b128 v[192:195], v6 offset:768
    v_xor_b32 v7, 32, v5
    ds_read_b128 v[36:39], v7 offset:0
    ds_read_b128 v[68:71], v7 offset:256
    ds_read_b128 v[164:167], v7 offset:512
    ds_read_b128 v[196:199], v7 offset:768
    s_waitcnt lgkmcnt(4)
    v_xor_b32 v6, 64, v5
    ds_read_b128 v[40:43], v6 offset:0
    ds_read_b128 v[72:75], v6 offset:256
    ds_read_b128 v[168:171], v6 offset:512
    ds_read_b128 v[200:203], v6 offset:768
    v_xor_b32 v7, 96, v5
    ds_read_b128 v[44:47], v7 offset:0
    ds_read_b128 v[76:79], v7 offset:256
    ds_read_b128 v[172:175], v7 offset:512
    ds_read_b128 v[204:207], v7 offset:768
    s_waitcnt lgkmcnt(4)
    v_xor_b32 v6, 128, v5
    ds_read_b128 v[48:51], v6 offset:0
    ds_read_b128 v[80:83], v6 offset:256
    ds_read_b128 v[176:179], v6 offset:512
    ds_read_b128 v[208:211], v6 offset:768
    v_xor_b32 v7, 160, v5
    ds_read_b128 v[52:55], v7 offset:0
    ds_read_b128 v[84:87], v7 offset:256
    ds_read_b128 v[180:183], v7 offset:512
    ds_read_b128 v[212:215], v7 offset:768
    s_waitcnt lgkmcnt(4)
    v_xor_b32 v6, 192, v5
    ds_read_b128 v[56:59], v6 offset:0
    ds_read_b128 v[88:91], v6 offset:256
    ds_read_b128 v[184:187], v6 offset:512
    ds_read_b128 v[216:219], v6 offset:768
    v_xor_b32 v7, 224, v5
    ds_read_b128 v[60:63], v7 offset:0
    ds_read_b128 v[92:95], v7 offset:256
    ds_read_b128 v[188:191], v7 offset:512
    ds_read_b128 v[220:223], v7 offset:768
    s_waitcnt lgkmcnt(4)
    s_waitcnt lgkmcnt(0)
L_skip_19:
    s_waitcnt vmcnt(16)
    s_barrier
    s_mov_b32 m0, s67
    s_nop 0
    buffer_load_dwordx4 v232, s[48:51], s66 offen offset:0 nt lds
    buffer_load_dwordx4 v233, s[48:51], s66 offen offset:1024 nt lds
    buffer_load_dwordx4 v234, s[48:51], s66 offen offset:2048 nt lds
    buffer_load_dwordx4 v235, s[48:51], s66 offen offset:3072 nt lds
    s_add_u32 s66, s66, 4096
    s_add_u32 s67, s67, 4096
    s_mov_b32 m0, s67
    s_nop 0
    buffer_load_dwordx4 v236, s[48:51], s66 offen offset:0 nt lds
    buffer_load_dwordx4 v237, s[48:51], s66 offen offset:1024 nt lds
    buffer_load_dwordx4 v238, s[48:51], s66 offen offset:2048 nt lds
    buffer_load_dwordx4 v239, s[48:51], s66 offen offset:3072 nt lds
    s_add_u32 s66, s66, 28672
    s_add_u32 s67, s67, 0x7000
    s_cmp_lg_u32 s3, 7
    s_cbranch_scc1 L_skip_20
    v_xor_b32 v6, 0, v5
    ds_read_b128 v[32:35], v6 offset:0
    ds_read_b128 v[64:67], v6 offset:256
    ds_read_b128 v[160:163], v6 offset:512
    ds_read_b128 v[192:195], v6 offset:768
    v_xor_b32 v7, 32, v5
    ds_read_b128 v[36:39], v7 offset:0
    ds_read_b128 v[68:71], v7 offset:256
    ds_read_b128 v[164:167], v7 offset:512
    ds_read_b128 v[196:199], v7 offset:768
    s_waitcnt lgkmcnt(4)
    v_xor_b32 v6, 64, v5
    ds_read_b128 v[40:43], v6 offset:0
    ds_read_b128 v[72:75], v6 offset:256
    ds_read_b128 v[168:171], v6 offset:512
    ds_read_b128 v[200:203], v6 offset:768
    v_xor_b32 v7, 96, v5
    ds_read_b128 v[44:47], v7 offset:0
    ds_read_b128 v[76:79], v7 offset:256
    ds_read_b128 v[172:175], v7 offset:512
    ds_read_b128 v[204:207], v7 offset:768
    s_waitcnt lgkmcnt(4)
    v_xor_b32 v6, 128, v5
    ds_read_b128 v[48:51], v6 offset:0
    ds_read_b128 v[80:83], v6 offset:256
    ds_read_b128 v[176:179], v6 offset:512
    ds_read_b128 v[208:211], v6 offset:768
    v_xor_b32 v7, 160, v5
    ds_read_b128 v[52:55], v7 offset:0
    ds_read_b128 v[84:87], v7 offset:256
    ds_read_b128 v[180:183], v7 offset:512
    ds_read_b128 v[212:215], v7 offset:768
    s_waitcnt lgkmcnt(4)
    v_xor_b32 v6, 192, v5
    ds_read_b128 v[56:59], v6 offset:0
    ds_read_b128 v[88:91], v6 offset:256
    ds_read_b128 v[184:187], v6 offset:512
    ds_read_b128 v[216:219], v6 offset:768
    v_xor_b32 v7, 224, v5
    ds_read_b128 v[60:63], v7 offset:0
    ds_read_b128 v[92:95], v7 offset:256
    ds_read_b128 v[188:191], v7 offset:512
    ds_read_b128 v[220:223], v7 offset:768
    s_waitcnt lgkmcnt(4)
    s_waitcnt lgkmcnt(0)
L_skip_20:
    s_barrier
    s_mov_b32 m0, s67
    s_nop 0
    buffer_load_dwordx4 v232, s[48:51], s66 offen offset:0 nt lds
    buffer_load_dwordx4 v233, s[48:51], s66 offen offset:1024 nt lds
    buffer_load_dwordx4 v234, s[48:51], s66 offen offset:2048 nt lds
    buffer_load_dwordx4 v235, s[48:51], s66 offen offset:3072 nt lds
    s_add_u32 s66, s66, 4096
    s_add_u32 s67, s67, 4096
    s_mov_b32 m0, s67
    s_nop 0
    buffer_load_dwordx4 v236, s[48:51], s66 offen offset:0 nt lds
    buffer_load_dwordx4 v237, s[48:51], s66 offen offset:1024 nt lds
    buffer_load_dwordx4 v238, s[48:51], s66 offen offset:2048 nt lds
    buffer_load_dwordx4 v239, s[48:51], s66 offen offset:3072 nt lds
    s_add_u32 s66, s66, 28672
    s_add_u32 s67, s67, 0x7000
    v_and_b32 v12, 15, v0
    v_lshlrev_b32 v12, 5, v12
    v_bfe_u32 v13, v0, 4, 1
    v_lshl_add_u32 v12, v13, 10, v12
    v_add_u32 v12, 131072, v12
    s_lshl_b32 s10, s5, 2
    v_add_u32 v13, s10, v12
    s_barrier
    v_xor_b32 v6, 0, v4
    ds_read_b128 v[224:227], v6 offset:0
    ds_read_b128 v[228:231], v6 offset:256
    v_xor_b32 v7, 32, v4
    ds_read_b128 v[232:235], v7 offset:0
    ds_read_b128 v[236:239], v7 offset:256
    s_waitcnt lgkmcnt(3)
    v_mfma_f32_32x32x16_bf16 v[16:31], v[32:35], v[224:227], 0
    v_xor_b32 v6, 64, v4
    ds_read_b128 v[32:35], v6 offset:0
    s_waitcnt lgkmcnt(3)
    v_mfma_f32_32x32x16_bf16 v[16:31], v[64:67], v[228:231], v[16:31]
    ds_read_b128 v[64:67], v6 offset:256
    s_waitcnt lgkmcnt(3)
    v_mfma_f32_32x32x16_bf16 v[16:31], v[36:39], v[232:235], v[16:31]
    v_xor_b32 v7, 96, v4
    ds_read_b128 v[36:39], v7 offset:0
    s_waitcnt lgkmcnt(3)
    v_mfma_f32_32x32x16_bf16 v[16:31], v[68:71], v[236:239], v[16:31]
    ds_read_b128 v[68:71], v7 offset:256
    s_waitcnt lgkmcnt(3)
    v_mfma_f32_32x32x16_bf16 v[16:31], v[40:43], v[32:35], v[16:31]
    v_xor_b32 v6, 128, v4
    ds_read_b128 v[40:43], v6 offset:0
    s_waitcnt lgkmcnt(3)
    v_mfma_f32_32x32x16_bf16 v[16:31], v[72:75], v[64:67], v[16:31]
    ds_read_b128 v[72:75], v6 offset:256
    s_waitcnt lgkmcnt(3)
    v_mfma_f32_32x32x16_bf16 v[16:31], v[44:47], v[36:39], v[16:31]
    v_xor_b32 v7, 160, v4
    ds_read_b128 v[44:47], v7 offset:0
    s_waitcnt lgkmcnt(3)
    v_mfma_f32_32x32x16_bf16 v[16:31], v[76:79], v[68:71], v[16:31]
    ds_read_b128 v[76:79], v7 offset:256
    s_waitcnt lgkmcnt(3)
    v_mfma_f32_32x32x16_bf16 v[16:31], v[48:51], v[40:43], v[16:31]
    v_xor_b32 v6, 192, v4
    ds_read_b128 v[48:51], v6 offset:0
    s_waitcnt lgkmcnt(3)
    v_mfma_f32_32x32x16_bf16 v[16:31], v[80:83], v[72:75], v[16:31]
    ds_read_b128 v[80:83], v6 offset:256
    s_waitcnt lgkmcnt(3)
    v_mfma_f32_32x32x16_bf16 v[16:31], v[52:55], v[44:47], v[16:31]
    v_xor_b32 v7, 224, v4
    ds_read_b128 v[52:55], v7 offset:0
    s_waitcnt lgkmcnt(3)
    v_mfma_f32_32x32x16_bf16 v[16:31], v[84:87], v[76:79], v[16:31]
    ds_read_b128 v[84:87], v7 offset:256
    s_waitcnt lgkmcnt(3)
    v_mfma_f32_32x32x16_bf16 v[16:31], v[56:59], v[48:51], v[16:31]
    v_xor_b32 v6, 0, v4
    ds_read_b128 v[56:59], v6 offset:512
    s_waitcnt lgkmcnt(3)
    v_mfma_f32_32x32x16_bf16 v[16:31], v[88:91], v[80:83], v[16:31]
    ds_read_b128 v[88:91], v6 offset:768
    s_waitcnt lgkmcnt(3)
    v_mfma_f32_32x32x16_bf16 v[16:31], v[60:63], v[52:55], v[16:31]
    v_xor_b32 v7, 32, v4
    ds_read_b128 v[60:63], v7 offset:512
    s_waitcnt lgkmcnt(3)
    v_mfma_f32_32x32x16_bf16 v[16:31], v[92:95], v[84:87], v[16:31]
    ds_read_b128 v[92:95], v7 offset:768
    s_waitcnt lgkmcnt(3)
    v_mfma_f32_32x32x16_bf16 v[16:31], v[160:163], v[56:59], v[16:31]
    s_barrier
    v_xor_b32 v6, 64, v4
    ds_read_b128 v[160:163], v6 offset:512
    s_waitcnt lgkmcnt(3)
    v_mfma_f32_32x32x16_bf16 v[16:31], v[192:195], v[88:91], v[16:31]
    ds_read_b128 v[192:195], v6 offset:768
    s_waitcnt lgkmcnt(3)
    v_mfma_f32_32x32x16_bf16 v[16:31], v[164:167], v[60:63], v[16:31]
    v_xor_b32 v7, 96, v4
    ds_read_b128 v[164:167], v7 offset:512
    s_waitcnt lgkmcnt(3)
    v_mfma_f32_32x32x16_bf16 v[16:31], v[196:199], v[92:95], v[16:31]
    ds_read_b128 v[196:199], v7 offset:768
    s_waitcnt lgkmcnt(3)
    v_mfma_f32_32x32x16_bf16 v[16:31], v[168:171], v[160:163], v[16:31]
    v_xor_b32 v6, 128, v4
    ds_read_b128 v[168:171], v6 offset:512
    s_waitcnt lgkmcnt(3)
    v_mfma_f32_32x32x16_bf16 v[16:31], v[200:203], v[192:195], v[16:31]
    ds_read_b128 v[200:203], v6 offset:768
    s_waitcnt lgkmcnt(3)
    v_mfma_f32_32x32x16_bf16 v[16:31], v[172:175], v[164:167], v[16:31]
    v_xor_b32 v7, 160, v4
    ds_read_b128 v[172:175], v7 offset:512
    s_waitcnt lgkmcnt(3)
    v_mfma_f32_32x32x16_bf16 v[16:31], v[204:207], v[196:199], v[16:31]
    ds_read_b128 v[204:207], v7 offset:768
    s_waitcnt lgkmcnt(3)
    v_mfma_f32_32x32x16_bf16 v[16:31], v[176:179], v[168:171], v[16:31]
    v_xor_b32 v6, 192, v4
    ds_read_b128 v[176:179], v6 offset:512
    s_waitcnt lgkmcnt(3)
    v_mfma_f32_32x32x16_bf16 v[16:31], v[208:211], v[200:203], v[16:31]
    ds_read_b128 v[208:211], v6 offset:768
    s_waitcnt lgkmcnt(3)
    v_mfma_f32_32x32x16_bf16 v[16:31], v[180:183], v[172:175], v[16:31]
    v_xor_b32 v7, 224, v4
    ds_read_b128 v[180:183], v7 offset:512
    s_waitcnt lgkmcnt(3)
    v_mfma_f32_32x32x16_bf16 v[16:31], v[212:215], v[204:207], v[16:31]
    ds_read_b128 v[212:215], v7 offset:768
    s_waitcnt lgkmcnt(3)
    v_mfma_f32_32x32x16_bf16 v[16:31], v[184:187], v[176:179], v[16:31]
    s_waitcnt lgkmcnt(2)
    v_mfma_f32_32x32x16_bf16 v[16:31], v[216:219], v[208:211], v[16:31]
    s_waitcnt lgkmcnt(1)
    v_mfma_f32_32x32x16_bf16 v[16:31], v[188:191], v[180:183], v[16:31]
    s_waitcnt lgkmcnt(0)
    v_mfma_f32_32x32x16_bf16 v[16:31], v[220:223], v[212:215], v[16:31]
    s_nop 11
    v_max3_f32 v10, v16, v17, v18
    v_max3_f32 v10, v10, v19, v20
    v_max3_f32 v10, v10, v21, v22
    v_max3_f32 v10, v10, v23, v24
    v_max3_f32 v10, v10, v25, v26
    v_max3_f32 v10, v10, v27, v28
    v_max3_f32 v10, v10, v29, v30
    v_max_f32 v10, v10, v31
    v_mov_b32 v11, v10
    s_nop 1
    v_permlane32_swap_b32 v10, v11
    v_max_f32 v10, v10, v11
    ds_write_b32 v13, v10 offset:0
    s_waitcnt lgkmcnt(0)
    s_barrier
    ds_read_b128 v[240:243], v12 offset:0
    v_mov_b32 v10, 155648
    v_mov_b32 v11, 0
    ds_write2_b32 v10, v11, v11 offset0:0 offset1:16
    ds_write2_b32 v10, v11, v11 offset0:32 offset1:48
    s_lshl_b32 s10, s5, 11
    s_add_u32 s10, s10, 133120
    v_lshl_add_u32 v11, v0, 4, s10
    s_waitcnt lgkmcnt(0)
    v_max3_f32 v8, v240, v241, v242
    v_max_f32 v8, v8, v243
    v_mul_f32 v8, s15, v8
    v_fma_f32 v16, v16, s15, -v8
    v_fma_f32 v17, v17, s15, -v8
    v_fma_f32 v18, v18, s15, -v8
    v_fma_f32 v19, v19, s15, -v8
    v_fma_f32 v20, v20, s15, -v8
    v_fma_f32 v21, v21, s15, -v8
    v_fma_f32 v22, v22, s15, -v8
    v_fma_f32 v23, v23, s15, -v8
    v_fma_f32 v24, v24, s15, -v8
    v_fma_f32 v25, v25, s15, -v8
    v_fma_f32 v26, v26, s15, -v8
    v_fma_f32 v27, v27, s15, -v8
    v_fma_f32 v28, v28, s15, -v8
    v_fma_f32 v29, v29, s15, -v8
    v_fma_f32 v30, v30, s15, -v8
    v_fma_f32 v31, v31, s15, -v8
    v_exp_f32 v16, v16
    v_exp_f32 v17, v17
    v_exp_f32 v18, v18
    v_exp_f32 v19, v19
    v_exp_f32 v20, v20
    v_exp_f32 v21, v21
    v_exp_f32 v22, v22
    v_exp_f32 v23, v23
    v_exp_f32 v24, v24
    v_exp_f32 v25, v25
    v_exp_f32 v26, v26
    v_exp_f32 v27, v27
    v_exp_f32 v28, v28
    v_exp_f32 v29, v29
    v_exp_f32 v30, v30
    v_exp_f32 v31, v31
    v_cvt_pk_bf16_f32 v240, v16, v17
    v_cvt_pk_bf16_f32 v241, v18, v19
    v_cvt_pk_bf16_f32 v242, v20, v21
    v_cvt_pk_bf16_f32 v243, v22, v23
    v_cvt_pk_bf16_f32 v244, v24, v25
    v_cvt_pk_bf16_f32 v245, v26, v27
    v_cvt_pk_bf16_f32 v246, v28, v29
    v_cvt_pk_bf16_f32 v247, v30, v31
    ds_write_b128 v11, v[240:243]
    ds_write_b128 v11, v[244:247] offset:1024
    s_waitcnt lgkmcnt(0)
    s_barrier
    v_add_f32 v16, v16, v17
    v_add_f32 v18, v18, v19
    v_add_f32 v20, v20, v21
    v_add_f32 v22, v22, v23
    v_add_f32 v24, v24, v25
    v_add_f32 v26, v26, v27
    v_add_f32 v28, v28, v29
    v_add_f32 v30, v30, v31
    v_add_f32 v16, v16, v18
    v_add_f32 v20, v20, v22
    v_add_f32 v24, v24, v26
    v_add_f32 v28, v28, v30
    v_add_f32 v16, v16, v20
    v_add_f32 v24, v24, v28
    v_add_f32 v16, v16, v24
    v_mov_b32 v3, v16
    s_waitcnt vmcnt(0)
    s_barrier
    v_xor_b32 v6, 0, v5
    ds_read_b128 v[240:243], v6 offset:0
    ds_read_b128 v[244:247], v6 offset:256
    v_xor_b32 v7, 32, v5
    ds_read_b128 v[248:251], v7 offset:0
    ds_read_b128 v[252:255], v7 offset:256
    s_waitcnt lgkmcnt(3)
    v_mfma_f32_32x32x16_bf16 v[16:31], v[240:243], v[224:227], 0
    v_xor_b32 v6, 64, v5
    ds_read_b128 v[240:243], v6 offset:0
    s_waitcnt lgkmcnt(3)
    v_mfma_f32_32x32x16_bf16 v[16:31], v[244:247], v[228:231], v[16:31]
    ds_read_b128 v[244:247], v6 offset:256
    s_waitcnt lgkmcnt(3)
    v_mfma_f32_32x32x16_bf16 v[16:31], v[248:251], v[232:235], v[16:31]
    v_xor_b32 v7, 96, v5
    ds_read_b128 v[248:251], v7 offset:0
    s_waitcnt lgkmcnt(3)
    v_mfma_f32_32x32x16_bf16 v[16:31], v[252:255], v[236:239], v[16:31]
    ds_read_b128 v[252:255], v7 offset:256
    s_waitcnt lgkmcnt(3)
    v_mfma_f32_32x32x16_bf16 v[16:31], v[240:243], v[32:35], v[16:31]
    v_xor_b32 v6, 128, v5
    ds_read_b128 v[240:243], v6 offset:0
    s_waitcnt lgkmcnt(3)
    v_mfma_f32_32x32x16_bf16 v[16:31], v[244:247], v[64:67], v[16:31]
    ds_read_b128 v[244:247], v6 offset:256
    s_waitcnt lgkmcnt(3)
    v_mfma_f32_32x32x16_bf16 v[16:31], v[248:251], v[36:39], v[16:31]
    v_xor_b32 v7, 160, v5
    ds_read_b128 v[248:251], v7 offset:0
    s_waitcnt lgkmcnt(3)
    v_mfma_f32_32x32x16_bf16 v[16:31], v[252:255], v[68:71], v[16:31]
    ds_read_b128 v[252:255], v7 offset:256
    s_waitcnt lgkmcnt(3)
    v_mfma_f32_32x32x16_bf16 v[16:31], v[240:243], v[40:43], v[16:31]
    v_xor_b32 v6, 192, v5
    ds_read_b128 v[240:243], v6 offset:0
    s_waitcnt lgkmcnt(3)
    v_mfma_f32_32x32x16_bf16 v[16:31], v[244:247], v[72:75], v[16:31]
    ds_read_b128 v[244:247], v6 offset:256
    s_waitcnt lgkmcnt(3)
    v_mfma_f32_32x32x16_bf16 v[16:31], v[248:251], v[44:47], v[16:31]
    v_xor_b32 v7, 224, v5
    ds_read_b128 v[248:251], v7 offset:0
    s_waitcnt lgkmcnt(3)
    v_mfma_f32_32x32x16_bf16 v[16:31], v[252:255], v[76:79], v[16:31]
    ds_read_b128 v[252:255], v7 offset:256
    s_waitcnt lgkmcnt(3)
    v_mfma_f32_32x32x16_bf16 v[16:31], v[240:243], v[48:51], v[16:31]
    v_xor_b32 v6, 0, v5
    ds_read_b128 v[240:243], v6 offset:512
    s_waitcnt lgkmcnt(3)
    v_mfma_f32_32x32x16_bf16 v[16:31], v[244:247], v[80:83], v[16:31]
    ds_read_b128 v[244:247], v6 offset:768
    s_waitcnt lgkmcnt(3)
    v_mfma_f32_32x32x16_bf16 v[16:31], v[248:251], v[52:55], v[16:31]
    v_xor_b32 v7, 32, v5
    ds_read_b128 v[248:251], v7 offset:512
    s_waitcnt lgkmcnt(3)
    v_mfma_f32_32x32x16_bf16 v[16:31], v[252:255], v[84:87], v[16:31]
    ds_read_b128 v[252:255], v7 offset:768
    s_waitcnt lgkmcnt(3)
    v_mfma_f32_32x32x16_bf16 v[16:31], v[240:243], v[56:59], v[16:31]
    v_xor_b32 v6, 64, v5
    ds_read_b128 v[240:243], v6 offset:512
    s_waitcnt lgkmcnt(3)
    v_mfma_f32_32x32x16_bf16 v[16:31], v[244:247], v[88:91], v[16:31]
    ds_read_b128 v[244:247], v6 offset:768
    s_waitcnt lgkmcnt(3)
    v_mfma_f32_32x32x16_bf16 v[16:31], v[248:251], v[60:63], v[16:31]
    v_xor_b32 v7, 96, v5
    ds_read_b128 v[248:251], v7 offset:512
    s_waitcnt lgkmcnt(3)
    v_mfma_f32_32x32x16_bf16 v[16:31], v[252:255], v[92:95], v[16:31]
    ds_read_b128 v[252:255], v7 offset:768
    s_waitcnt lgkmcnt(3)
    v_mfma_f32_32x32x16_bf16 v[16:31], v[240:243], v[160:163], v[16:31]
    v_xor_b32 v6, 128, v5
    ds_read_b128 v[240:243], v6 offset:512
    s_waitcnt lgkmcnt(3)
    v_mfma_f32_32x32x16_bf16 v[16:31], v[244:247], v[192:195], v[16:31]
    ds_read_b128 v[244:247], v6 offset:768
    s_waitcnt lgkmcnt(3)
    v_mfma_f32_32x32x16_bf16 v[16:31], v[248:251], v[164:167], v[16:31]
    v_xor_b32 v7, 160, v5
    ds_read_b128 v[248:251], v7 offset:512
    s_waitcnt lgkmcnt(3)
    v_mfma_f32_32x32x16_bf16 v[16:31], v[252:255], v[196:199], v[16:31]
    ds_read_b128 v[252:255], v7 offset:768
    s_waitcnt lgkmcnt(3)
    v_mfma_f32_32x32x16_bf16 v[16:31], v[240:243], v[168:171], v[16:31]
    v_xor_b32 v6, 192, v5
    ds_read_b128 v[240:243], v6 offset:512
    s_waitcnt lgkmcnt(3)
    v_mfma_f32_32x32x16_bf16 v[16:31], v[244:247], v[200:203], v[16:31]
    ds_read_b128 v[244:247], v6 offset:768
    s_waitcnt lgkmcnt(3)
    v_mfma_f32_32x32x16_bf16 v[16:31], v[248:251], v[172:175], v[16:31]
    v_xor_b32 v7, 224, v5
    ds_read_b128 v[248:251], v7 offset:512
    s_waitcnt lgkmcnt(3)
    v_mfma_f32_32x32x16_bf16 v[16:31], v[252:255], v[204:207], v[16:31]
    ds_read_b128 v[252:255], v7 offset:768
    s_waitcnt lgkmcnt(3)
    v_mfma_f32_32x32x16_bf16 v[16:31], v[240:243], v[176:179], v[16:31]
    s_waitcnt lgkmcnt(2)
    v_mfma_f32_32x32x16_bf16 v[16:31], v[244:247], v[208:211], v[16:31]
    s_waitcnt lgkmcnt(1)
    v_mfma_f32_32x32x16_bf16 v[16:31], v[248:251], v[180:183], v[16:31]
    s_waitcnt lgkmcnt(0)
    v_mfma_f32_32x32x16_bf16 v[16:31], v[252:255], v[212:215], v[16:31]
    s_nop 11
    v_max3_f32 v10, v16, v17, v18
    v_max3_f32 v10, v10, v19, v20
    v_max3_f32 v10, v10, v21, v22
    v_max3_f32 v10, v10, v23, v24
    v_max3_f32 v10, v10, v25, v26
    v_max3_f32 v10, v10, v27, v28
    v_max3_f32 v10, v10, v29, v30
    v_max_f32 v10, v10, v31
    v_mov_b32 v11, v10
    s_nop 1
    v_permlane32_swap_b32 v10, v11
    v_max_f32 v10, v10, v11
    ds_write_b32 v13, v10 offset:16
    s_waitcnt lgkmcnt(0)
    s_barrier
    ds_read_b128 v[240:243], v12 offset:16
    s_lshl_b32 s10, s5, 11
    s_add_u32 s10, s10, 141312
    v_lshl_add_u32 v11, v0, 4, s10
    s_waitcnt lgkmcnt(0)
    v_max3_f32 v10, v240, v241, v242
    v_max_f32 v10, v10, v243
    v_mul_f32 v10, s15, v10
    v_max_f32 v10, v10, v8
    v_sub_f32 v8, v8, v10
    v_exp_f32 v240, v8
    v_mov_b32 v8, v10
    v_mul_f32 v3, v3, v240
    v_fma_f32 v16, v16, s15, -v8
    v_fma_f32 v17, v17, s15, -v8
    v_fma_f32 v18, v18, s15, -v8
    v_fma_f32 v19, v19, s15, -v8
    v_fma_f32 v20, v20, s15, -v8
    v_fma_f32 v21, v21, s15, -v8
    v_fma_f32 v22, v22, s15, -v8
    v_fma_f32 v23, v23, s15, -v8
    v_fma_f32 v24, v24, s15, -v8
    v_fma_f32 v25, v25, s15, -v8
    v_fma_f32 v26, v26, s15, -v8
    v_fma_f32 v27, v27, s15, -v8
    v_fma_f32 v28, v28, s15, -v8
    v_fma_f32 v29, v29, s15, -v8
    v_fma_f32 v30, v30, s15, -v8
    v_fma_f32 v31, v31, s15, -v8
    v_exp_f32 v16, v16
    v_exp_f32 v17, v17
    v_exp_f32 v18, v18
    v_exp_f32 v19, v19
    v_exp_f32 v20, v20
    v_exp_f32 v21, v21
    v_exp_f32 v22, v22
    v_exp_f32 v23, v23
    v_exp_f32 v24, v24
    v_exp_f32 v25, v25
    v_exp_f32 v26, v26
    v_exp_f32 v27, v27
    v_exp_f32 v28, v28
    v_exp_f32 v29, v29
    v_exp_f32 v30, v30
    v_exp_f32 v31, v31
    v_cvt_pk_bf16_f32 v240, v16, v17
    v_cvt_pk_bf16_f32 v241, v18, v19
    v_cvt_pk_bf16_f32 v242, v20, v21
    v_cvt_pk_bf16_f32 v243, v22, v23
    v_cvt_pk_bf16_f32 v244, v24, v25
    v_cvt_pk_bf16_f32 v245, v26, v27
    v_cvt_pk_bf16_f32 v246, v28, v29
    v_cvt_pk_bf16_f32 v247, v30, v31
    ds_write_b128 v11, v[240:243]
    ds_write_b128 v11, v[244:247] offset:1024
    v_add_f32 v16, v16, v17
    v_add_f32 v18, v18, v19
    v_add_f32 v20, v20, v21
    v_add_f32 v22, v22, v23
    v_add_f32 v24, v24, v25
    v_add_f32 v26, v26, v27
    v_add_f32 v28, v28, v29
    v_add_f32 v30, v30, v31
    v_add_f32 v16, v16, v18
    v_add_f32 v20, v20, v22
    v_add_f32 v24, v24, v26
    v_add_f32 v28, v28, v30
    v_add_f32 v16, v16, v20
    v_add_f32 v24, v24, v28
    v_add_f32 v16, v16, v24
    v_add_f32 v16, v16, v3
    v_mov_b32 v10, v16
    s_nop 1
    v_permlane32_swap_b32 v16, v10
    v_add_f32 v16, v16, v10
    ds_write_b32 v13, v16 offset:20480
    s_waitcnt lgkmcnt(0)
    s_barrier
    s_endpgm
L_Q_REST:
    s_mov_b32 s15, 0x3e0293ee
    s_mov_b32 s14, 20000
    v_and_b32 v3, 1, v0
    v_cmp_eq_u32 vcc, 1, v3
    v_mov_b32 v8, 0x0c0c0100
    v_mov_b32 v3, 0x01000c0c
    v_cndmask_b32 v8, v8, v3, vcc
    v_add_u32 v9, 0x0202, v8
    v_mov_b32 v3, 0x03020c0c
    v_cndmask_b32 v9, v9, v3, vcc
    v_and_b32 v3, 2, v0
    v_cmp_eq_u32 vcc, 0, v3
    v_mov_b32 v3, 0x0c0c0c0c
    s_nop 0
    v_cndmask_b32 v4, v3, v8, vcc
    v_cndmask_b32 v5, v8, v3, vcc
    v_cndmask_b32 v6, v3, v9, vcc
    v_cndmask_b32 v7, v9, v3, vcc
    v_mov_b32 v14, 0
    v_mov_b32 v15, 0
    ds_write_b64 v14, v[14:15] offset:9472
    s_waitcnt lgkmcnt(0)
    s_add_u32 s94, s94, 1
    s_xor_b32 s95, s94, 0x5bd1e995
    s_mov_b32 s72, 0x3030303
    s_mov_b32 s73, 0x3030303
    s_mov_b32 s74, 0xc0c0c0c
    s_mov_b32 s75, 0xc0c0c0c
    s_mov_b32 s76, 0x30303030
    s_mov_b32 s77, 0x30303030
    s_mov_b32 s78, 0xc0c0c0c0
    s_mov_b32 s79, 0xc0c0c0c0
    s_lshl_b32 s10, s3, 10
    v_add_u32 v31, s10, v2
    s_waitcnt vmcnt(8)
    v_perm_b32 v228, v24, v24, v8
    v_cndmask_b32 v230, 0, v228, s[72:73]
    v_cndmask_b32 v231, 0, v228, s[74:75]
    v_cndmask_b32 v232, 0, v228, s[76:77]
    v_cndmask_b32 v233, 0, v228, s[78:79]
    s_waitcnt vmcnt(7)
    s_nop 0
    v_mfma_f32_16x16x32_bf16 v[18:21], v[230:233], v[132:135], 0
    v_perm_b32 v228, v24, v24, v9
    v_cndmask_b32 v234, 0, v228, s[72:73]
    v_cndmask_b32 v235, 0, v228, s[74:75]
    v_cndmask_b32 v236, 0, v228, s[76:77]
    v_cndmask_b32 v237, 0, v228, s[78:79]
    s_waitcnt vmcnt(6)
    s_nop 0
    v_mfma_f32_16x16x32_bf16 v[18:21], v[234:237], v[136:139], v[18:21]
    v_perm_b32 v228, v25, v25, v8
    v_cndmask_b32 v230, 0, v228, s[72:73]
    v_cndmask_b32 v231, 0, v228, s[74:75]
    v_cndmask_b32 v232, 0, v228, s[76:77]
    v_cndmask_b32 v233, 0, v228, s[78:79]
    s_waitcnt vmcnt(5)
    s_nop 0
    v_mfma_f32_16x16x32_bf16 v[18:21], v[230:233], v[140:143], v[18:21]
    v_perm_b32 v228, v25, v25, v9
    v_cndmask_b32 v234, 0, v228, s[72:73]
    v_cndmask_b32 v235, 0, v228, s[74:75]
    v_cndmask_b32 v236, 0, v228, s[76:77]
    v_cndmask_b32 v237, 0, v228, s[78:79]
    s_waitcnt vmcnt(4)
    s_nop 0
    v_mfma_f32_16x16x32_bf16 v[18:21], v[234:237], v[144:147], v[18:21]
    v_perm_b32 v228, v26, v26, v8
    v_cndmask_b32 v230, 0, v228, s[72:73]
    v_cndmask_b32 v231, 0, v228, s[74:75]
    v_cndmask_b32 v232, 0, v228, s[76:77]
    v_cndmask_b32 v233, 0, v228, s[78:79]
    s_waitcnt vmcnt(3)
    s_nop 0
    v_mfma_f32_16x16x32_bf16 v[18:21], v[230:233], v[148:151], v[18:21]
    v_perm_b32 v228, v26, v26, v9
    v_cndmask_b32 v234, 0, v228, s[72:73]
    v_cndmask_b32 v235, 0, v228, s[74:75]
    v_cndmask_b32 v236, 0, v228, s[76:77]
    v_cndmask_b32 v237, 0, v228, s[78:79]
    s_waitcnt vmcnt(2)
    s_nop 0
    v_mfma_f32_16x16x32_bf16 v[18:21], v[234:237], v[152:155], v[18:21]
    v_perm_b32 v228, v27, v27, v8
    v_cndmask_b32 v230, 0, v228, s[72:73]
    v_cndmask_b32 v231, 0, v228, s[74:75]
    v_cndmask_b32 v232, 0, v228, s[76:77]
    v_cndmask_b32 v233, 0, v228, s[78:79]
    s_waitcnt vmcnt(1)
    s_nop 0
    v_mfma_f32_16x16x32_bf16 v[18:21], v[230:233], v[156:159], v[18:21]
    v_perm_b32 v228, v27, v27, v9
    v_cndmask_b32 v234, 0, v228, s[72:73]
    v_cndmask_b32 v235, 0, v228, s[74:75]
    v_cndmask_b32 v236, 0, v228, s[76:77]
    v_cndmask_b32 v237, 0, v228, s[78:79]
    s_waitcnt vmcnt(0)
    s_nop 0
    v_mfma_f32_16x16x32_bf16 v[18:21], v[234:237], v[160:163], v[18:21]
    s_nop 7
    ds_write_b128 v31, v[18:21] offset:0
    s_waitcnt vmcnt(15)
    s_mov_b32 m0, s71
    s_nop 0
    buffer_load_dwordx4 v30, s[56:59], s70 offen nt lds
    s_add_u32 s70, s70, s69
    s_add_u32 s71, s71, 1024
    s_waitcnt vmcnt(15)
    s_mov_b32 m0, s71
    s_nop 0
    buffer_load_dwordx4 v30, s[56:59], s70 offen nt lds
    s_add_u32 s70, s70, s69
    s_add_u32 s71, s71, 1024
    s_waitcnt vmcnt(15)
    s_mov_b32 m0, s71
    s_nop 0
    buffer_load_dwordx4 v30, s[56:59], s70 offen nt lds
    s_add_u32 s70, s70, s69
    s_add_u32 s71, s71, 1024
    s_waitcnt vmcnt(15)
    s_mov_b32 m0, s71
    s_nop 0
    buffer_load_dwordx4 v30, s[56:59], s70 offen nt lds
    s_add_u32 s70, s70, s69
    s_add_u32 s71, s71, 1024
    s_waitcnt vmcnt(15)
    s_mov_b32 m0, s71
    s_nop 0
    buffer_load_dwordx4 v30, s[56:59], s70 offen nt lds
    s_add_u32 s70, s70, s69
    s_add_u32 s71, s71, 1024
    s_waitcnt vmcnt(15)
    s_mov_b32 m0, s71
    s_nop 0
    buffer_load_dwordx4 v30, s[56:59], s70 offen nt lds
    s_add_u32 s70, s70, s69
    s_add_u32 s71, s71, 1024
    s_waitcnt vmcnt(15)
    s_mov_b32 m0, s71
    s_nop 0
    buffer_load_dwordx4 v30, s[56:59], s70 offen nt lds
    s_add_u32 s70, s70, s69
    s_add_u32 s71, s71, 1024
    s_waitcnt vmcnt(15)
    s_mov_b32 m0, s71
    s_nop 0
    buffer_load_dwordx4 v30, s[56:59], s70 offen nt lds
    s_add_u32 s70, s70, s69
    s_add_u32 s71, s71, 1024
    s_waitcnt lgkmcnt(0)
    s_barrier
    s_cmp_lg_u32 s3, 0
    s_cbranch_scc1 L_skip_21
    ds_read_b128 v[132:135], v2 offset:0
    ds_read_b128 v[136:139], v2 offset:1024
    ds_read_b128 v[140:143], v2 offset:2048
    ds_read_b128 v[144:147], v2 offset:3072
    ds_read_b128 v[148:151], v2 offset:4096
    ds_read_b128 v[152:155], v2 offset:5120
    ds_read_b128 v[156:159], v2 offset:6144
    ds_read_b128 v[160:163], v2 offset:7168
    v_lshrrev_b32 v246, 5, v0
    v_lshlrev_b32 v246, 14, v246
    v_and_b32 v247, 15, v0
    v_lshl_add_u32 v246, v247, 5, v246
    v_bfe_u32 v247, v0, 4, 1
    v_lshl_add_u32 v246, v247, 4, v246
    s_lshl_b32 s10, s4, 15
    s_lshl_b32 s11, s13, 9
    s_add_u32 s10, s10, s11
    s_add_u32 s10, s10, 0
    s_sub_u32 s12, s2, 192
    s_lshr_b32 s13, s12, 3
    s_and_b32 s12, s12, 7
    s_waitcnt lgkmcnt(0)
    v_add_f32 v132, v132, v136
    v_add_f32 v133, v133, v137
    v_add_f32 v134, v134, v138
    v_add_f32 v135, v135, v139
    v_add_f32 v140, v140, v144
    v_add_f32 v141, v141, v145
    v_add_f32 v142, v142, v146
    v_add_f32 v143, v143, v147
    v_add_f32 v148, v148, v152
    v_add_f32 v149, v149, v153
    v_add_f32 v150, v150, v154
    v_add_f32 v151, v151, v155
    v_add_f32 v156, v156, v160
    v_add_f32 v157, v157, v161
    v_add_f32 v158, v158, v162
    v_add_f32 v159, v159, v163
    v_add_f32 v132, v132, v140
    v_add_f32 v133, v133, v141
    v_add_f32 v134, v134, v142
    v_add_f32 v135, v135, v143
    v_add_f32 v148, v148, v156
    v_add_f32 v149, v149, v157
    v_add_f32 v150, v150, v158
    v_add_f32 v151, v151, v159
    v_add_f32 v132, v132, v148
    v_add_f32 v133, v133, v149
    v_add_f32 v134, v134, v150
    v_add_f32 v135, v135, v151
    buffer_store_dwordx4 v[132:135], v246, s[44:47], s10 offen sc1
    s_waitcnt vmcnt(0)
    v_mov_b32 v246, s94
    v_mov_b32 v247, s95
    s_lshl_b32 s10, s13, 7
    s_lshl_b32 s11, s12, 3
    s_add_u32 s10, s10, s11
    s_add_u32 s10, s10, 327680
    s_mov_b64 exec, 1
    buffer_store_dwordx2 v[246:247], off, s[44:47], s10 sc1
    s_mov_b64 exec, -1
L_skip_21:
    s_waitcnt vmcnt(7)
    s_mov_b32 m0, s71
    s_nop 0
    buffer_load_dwordx4 v30, s[56:59], s70 offen nt lds
    s_add_u32 s70, s70, s69
    s_add_u32 s71, s71, 1024
    s_waitcnt vmcnt(7)
    s_mov_b32 m0, s71
    s_nop 0
    buffer_load_dwordx4 v30, s[56:59], s70 offen nt lds
    s_add_u32 s70, s70, s69
    s_add_u32 s71, s71, 1024
    s_waitcnt vmcnt(7)
    s_mov_b32 m0, s71
    s_nop 0
    buffer_load_dwordx4 v30, s[56:59], s70 offen nt lds
    s_add_u32 s70, s70, s69
    s_add_u32 s71, s71, 1024
    s_waitcnt vmcnt(7)
    s_mov_b32 m0, s71
    s_nop 0
    buffer_load_dwordx4 v30, s[56:59], s70 offen nt lds
    s_add_u32 s70, s70, s69
    s_add_u32 s71, s71, 1024
    s_waitcnt vmcnt(7)
    s_mov_b32 m0, s71
    s_nop 0
    buffer_load_dwordx4 v30, s[56:59], s70 offen nt lds
    s_add_u32 s70, s70, s69
    s_add_u32 s71, s71, 1024
    s_waitcnt vmcnt(7)
    s_mov_b32 m0, s71
    s_nop 0
    buffer_load_dwordx4 v30, s[56:59], s70 offen nt lds
    s_add_u32 s70, s70, s69
    s_add_u32 s71, s71, 1024
    s_waitcnt vmcnt(7)
    s_mov_b32 m0, s71
    s_nop 0
    buffer_load_dwordx4 v30, s[56:59], s70 offen nt lds
    s_add_u32 s70, s70, s69
    s_add_u32 s71, s71, 1024
    s_waitcnt vmcnt(7)
    s_mov_b32 m0, s71
    s_nop 0
    buffer_load_dwordx4 v30, s[56:59], s70 offen nt lds
    s_add_u32 s70, s70, s69
    s_add_u32 s71, s71, 1024
    s_cmp_eq_u32 s9, 11
    s_cbranch_scc1 L_Q_B
    s_waitcnt vmcnt(4)
    buffer_load_dwordx4 v[36:39], v1, s[48:51], s5 offen offset:0 nt
    s_add_u32 s5, s5, 8192
    s_waitcnt vmcnt(4)
    buffer_load_dwordx4 v[40:43], v1, s[48:51], s5 offen offset:0 nt
    s_add_u32 s5, s5, 8192
    s_waitcnt vmcnt(4)
    buffer_load_dwordx4 v[44:47], v1, s[48:51], s5 offen offset:0 nt
    s_add_u32 s5, s5, 8192
    s_waitcnt vmcnt(4)
    buffer_load_dwordx4 v[48:51], v1, s[48:51], s5 offen offset:0 nt
    s_add_u32 s5, s5, 8192
    s_waitcnt vmcnt(4)
    buffer_load_dwordx4 v[52:55], v1, s[48:51], s5 offen offset:0 nt
    s_add_u32 s5, s5, 8192
    s_waitcnt vmcnt(4)
    buffer_load_dwordx4 v[56:59], v1, s[48:51], s5 offen offset:0 nt
    s_add_u32 s5, s5, 8192
    s_waitcnt vmcnt(4)
    buffer_load_dwordx4 v[60:63], v1, s[48:51], s5 offen offset:0 nt
    s_add_u32 s5, s5, 8192
    s_cmp_eq_u32 s3, 0
    s_cselect_b32 s13, 0, 0x40000000
    s_lshl_b32 s12, s7, 7
    s_add_u32 s12, s12, 327680
    s_add_u32 s12, s12, s13
    v_lshlrev_b32 v26, 3, v0
    s_mov_b64 exec, 0xffff
    buffer_load_dwordx2 v[24:25], v26, s[44:47], s12 offen sc1
    s_mov_b64 exec, -1
    s_waitcnt vmcnt(5)
    s_waitcnt vmcnt(4)
    buffer_load_dwordx4 v[64:67], v1, s[48:51], s5 offen offset:0 nt
    s_add_u32 s5, s5, 8192
    s_waitcnt vmcnt(4)
    buffer_load_dwordx4 v[68:71], v1, s[48:51], s5 offen offset:0 nt
    s_add_u32 s5, s5, 8192
    s_waitcnt vmcnt(4)
    buffer_load_dwordx4 v[72:75], v1, s[48:51], s5 offen offset:0 nt
    s_add_u32 s5, s5, 8192
    s_waitcnt vmcnt(4)
    buffer_load_dwordx4 v[76:79], v1, s[48:51], s5 offen offset:0 nt
    s_add_u32 s5, s5, 8192
    s_lshl_b32 s10, s8, 14
    s_lshl_b32 s11, s7, 11
    s_add_u32 s10, s10, s11
    s_add_u32 s10, s10, 0
    s_add_u32 s10, s10, s13
    s_add_u32 s11, s10, 32768
    v_lshlrev_b32 v3, 5, v0
    s_waitcnt vmcnt(4)
    s_cmp_lg_u32 s3, 0
    s_cbranch_scc1 L_ok_23
    s_mov_b64 exec, 0xffff
L_spin_22:
    v_cmp_ne_u64 vcc, s[94:95], v[24:25]
    s_cbranch_vccz L_ok_23
    buffer_load_dwordx2 v[24:25], v26, s[44:47], s12 offen sc1
    s_waitcnt vmcnt(0)
    s_sub_u32 s14, s14, 1
    s_cbranch_scc0 L_spin_22
L_ok_23:
    s_mov_b64 exec, -1
    buffer_load_dwordx4 v[228:231], v3, s[44:47], s10 offen offset:0 sc1
    buffer_load_dwordx4 v[232:235], v3, s[44:47], s10 offen offset:16 sc1
    buffer_load_dwordx4 v[236:239], v3, s[44:47], s11 offen offset:0 sc1
    buffer_load_dwordx4 v[240:243], v3, s[44:47], s11 offen offset:16 sc1
    s_waitcnt vmcnt(7)
    buffer_load_dwordx4 v[80:83], v1, s[48:51], s5 offen offset:0 nt
    s_add_u32 s5, s5, 8192
    s_waitcnt vmcnt(7)
    buffer_load_dwordx4 v[84:87], v1, s[48:51], s5 offen offset:0 nt
    s_add_u32 s5, s5, 8192
    s_waitcnt vmcnt(7)
    buffer_load_dwordx4 v[88:91], v1, s[48:51], s5 offen offset:0 nt
    s_add_u32 s5, s5, 8192
    s_waitcnt vmcnt(7)
    buffer_load_dwordx4 v[92:95], v1, s[48:51], s5 offen offset:0 nt
    s_add_u32 s5, s5, 8192
    s_cmp_lg_u32 s3, 0
    s_cbranch_scc1 L_skip_24
    s_waitcnt vmcnt(4)
    v_add_f32 v228, v228, v236
    v_add_f32 v229, v229, v237
    v_add_f32 v230, v230, v238
    v_add_f32 v231, v231, v239
    v_add_f32 v232, v232, v240
    v_add_f32 v233, v233, v241
    v_add_f32 v234, v234, v242
    v_add_f32 v235, v235, v243
    v_cvt_pk_bf16_f32 v228, v228, v229
    v_cvt_pk_bf16_f32 v229, v230, v231
    v_cvt_pk_bf16_f32 v230, v232, v233
    v_cvt_pk_bf16_f32 v231, v234, v235
    v_mov_b32 v24, 0
    v_mov_b32 v25, 1
    ds_write_b128 v2, v[228:231] offset:8192
    s_waitcnt lgkmcnt(0)
    ds_write_b32 v24, v25 offset:9472
L_skip_24:
    s_waitcnt vmcnt(3)
    buffer_load_dwordx4 v[96:99], v1, s[48:51], s5 offen offset:0 nt
    s_add_u32 s5, s5, 8192
    s_waitcnt vmcnt(3)
    buffer_load_dwordx4 v[100:103], v1, s[48:51], s5 offen offset:0 nt
    s_waitcnt vmcnt(3)
    buffer_load_dwordx4 v[132:135], v2, s[52:55], s6 offen offset:0 nt
    s_add_u32 s6, s6, 8192
    s_waitcnt vmcnt(3)
    buffer_load_dwordx4 v[136:139], v2, s[52:55], s6 offen offset:0 nt
    s_add_u32 s6, s6, 8192
    s_waitcnt vmcnt(3)
    buffer_load_dwordx4 v[140:143], v2, s[52:55], s6 offen offset:0 nt
    s_add_u32 s6, s6, 8192
    v_mov_b32 v24, 0
    s_mov_b32 s14, 400000
L_spin_25:
    ds_read_b32 v25, v24 offset:9472
    ds_read_b128 v[10:13], v1 offset:8192
    s_waitcnt lgkmcnt(0)
    v_cmp_eq_u32 vcc, 0, v25
    s_cbranch_vccz L_ok_26
    s_sleep 1
    s_sub_u32 s14, s14, 1
    s_cbranch_scc0 L_spin_25
L_ok_26:
    v_bfe_u32 v29, v0, 2, 2
    v_lshlrev_b32 v29, 5, v29
    s_lshl_b32 s10, s3, 2
    v_add_u32 v30, s10, v29
    v_mov_b32 v228, 0
    v_mov_b32 v229, 0
    v_mov_b32 v232, 0
    v_mov_b32 v233, 0
    v_mov_b32 v236, 0
    v_mov_b32 v237, 0
    v_mov_b32 v240, 0
    v_mov_b32 v241, 0
    v_mov_b32 v244, 0
    v_mov_b32 v245, 0
    buffer_load_dwordx4 v[144:147], v2, s[52:55], s6 offen offset:0 nt
    s_add_u32 s6, s6, 8192
    buffer_load_dwordx4 v[148:151], v2, s[52:55], s6 offen offset:0 nt
    s_add_u32 s6, s6, 8192
    v_mfma_f32_16x16x32_bf16 v[32:35], v[36:39], v[10:13], 0
    v_mfma_f32_16x16x32_bf16 v[36:39], v[40:43], v[10:13], 0
    v_mfma_f32_16x16x32_bf16 v[40:43], v[44:47], v[10:13], 0
    v_mfma_f32_16x16x32_bf16 v[44:47], v[48:51], v[10:13], 0
    buffer_load_dwordx4 v[152:155], v2, s[52:55], s6 offen offset:0 nt
    s_add_u32 s6, s6, 8192
    buffer_load_dwordx4 v[156:159], v2, s[52:55], s6 offen offset:0 nt
    s_add_u32 s6, s6, 8192
    v_mfma_f32_16x16x32_bf16 v[48:51], v[52:55], v[10:13], 0
    v_mfma_f32_16x16x32_bf16 v[52:55], v[56:59], v[10:13], 0
    v_mfma_f32_16x16x32_bf16 v[56:59], v[60:63], v[10:13], 0
    v_mfma_f32_16x16x32_bf16 v[60:63], v[64:67], v[10:13], 0
    v_mov_b32_dpp v32, v32 quad_perm:[0,0,0,0] row_mask:0xf bank_mask:0xf
    v_mov_b32_dpp v36, v36 quad_perm:[0,0,0,0] row_mask:0xf bank_mask:0xf
    v_mov_b32_dpp v40, v40 quad_perm:[0,0,0,0] row_mask:0xf bank_mask:0xf
    v_mov_b32_dpp v44, v44 quad_perm:[0,0,0,0] row_mask:0xf bank_mask:0xf
    v_add_f32_dpp v32, v33, v32 quad_perm:[1,1,1,1] row_mask:0xf bank_mask:0xf
    v_add_f32_dpp v36, v37, v36 quad_perm:[1,1,1,1] row_mask:0xf bank_mask:0xf
    v_add_f32_dpp v40, v41, v40 quad_perm:[1,1,1,1] row_mask:0xf bank_mask:0xf
    v_add_f32_dpp v44, v45, v44 quad_perm:[1,1,1,1] row_mask:0xf bank_mask:0xf
    v_add_f32_dpp v32, v34, v32 quad_perm:[2,2,2,2] row_mask:0xf bank_mask:0xf
    v_add_f32_dpp v36, v38, v36 quad_perm:[2,2,2,2] row_mask:0xf bank_mask:0xf
    v_add_f32_dpp v40, v42, v40 quad_perm:[2,2,2,2] row_mask:0xf bank_mask:0xf
    v_add_f32_dpp v44, v46, v44 quad_perm:[2,2,2,2] row_mask:0xf bank_mask:0xf
    v_add_f32_dpp v32, v35, v32 quad_perm:[3,3,3,3] row_mask:0xf bank_mask:0xf
    v_add_f32_dpp v36, v39, v36 quad_perm:[3,3,3,3] row_mask:0xf bank_mask:0xf
    v_add_f32_dpp v40, v43, v40 quad_perm:[3,3,3,3] row_mask:0xf bank_mask:0xf
    v_add_f32_dpp v44, v47, v44 quad_perm:[3,3,3,3] row_mask:0xf bank_mask:0xf
    v_max3_f32 v23, v32, v36, v40
    v_max_f32 v23, v23, v44
    buffer_load_dwordx4 v[160:163], v2, s[52:55], s6 offen offset:0 nt
    s_add_u32 s6, s6, 8192
    buffer_load_dwordx4 v[164:167], v2, s[52:55], s6 offen offset:0 nt
    s_add_u32 s6, s6, 8192
    v_mfma_f32_16x16x32_bf16 v[64:67], v[68:71], v[10:13], 0
    v_mfma_f32_16x16x32_bf16 v[68:71], v[72:75], v[10:13], 0
    v_mfma_f32_16x16x32_bf16 v[72:75], v[76:79], v[10:13], 0
    v_mfma_f32_16x16x32_bf16 v[76:79], v[80:83], v[10:13], 0
    v_mov_b32_dpp v48, v48 quad_perm:[0,0,0,0] row_mask:0xf bank_mask:0xf
    v_mov_b32_dpp v52, v52 quad_perm:[0,0,0,0] row_mask:0xf bank_mask:0xf
    v_mov_b32_dpp v56, v56 quad_perm:[0,0,0,0] row_mask:0xf bank_mask:0xf
    v_mov_b32_dpp v60, v60 quad_perm:[0,0,0,0] row_mask:0xf bank_mask:0xf
    v_add_f32_dpp v48, v49, v48 quad_perm:[1,1,1,1] row_mask:0xf bank_mask:0xf
    v_add_f32_dpp v52, v53, v52 quad_perm:[1,1,1,1] row_mask:0xf bank_mask:0xf
    v_add_f32_dpp v56, v57, v56 quad_perm:[1,1,1,1] row_mask:0xf bank_mask:0xf
    v_add_f32_dpp v60, v61, v60 quad_perm:[1,1,1,1] row_mask:0xf bank_mask:0xf
    v_add_f32_dpp v48, v50, v48 quad_perm:[2,2,2,2] row_mask:0xf bank_mask:0xf
    v_add_f32_dpp v52, v54, v52 quad_perm:[2,2,2,2] row_mask:0xf bank_mask:0xf
    v_add_f32_dpp v56, v58, v56 quad_perm:[2,2,2,2] row_mask:0xf bank_mask:0xf
    v_add_f32_dpp v60, v62, v60 quad_perm:[2,2,2,2] row_mask:0xf bank_mask:0xf
    v_add_f32_dpp v48, v51, v48 quad_perm:[3,3,3,3] row_mask:0xf bank_mask:0xf
    v_add_f32_dpp v52, v55, v52 quad_perm:[3,3,3,3] row_mask:0xf bank_mask:0xf
    v_add_f32_dpp v56, v59, v56 quad_perm:[3,3,3,3] row_mask:0xf bank_mask:0xf
    v_add_f32_dpp v60, v63, v60 quad_perm:[3,3,3,3] row_mask:0xf bank_mask:0xf
    v_max3_f32 v23, v23, v48, v52
    v_max3_f32 v23, v23, v56, v60
    buffer_load_dwordx4 v[168:171], v2, s[52:55], s6 offen offset:0 nt
    s_add_u32 s6, s6, 8192
    buffer_load_dwordx4 v[172:175], v2, s[52:55], s6 offen offset:0 nt
    s_add_u32 s6, s6, 8192
    v_mfma_f32_16x16x32_bf16 v[80:83], v[84:87], v[10:13], 0
    v_mfma_f32_16x16x32_bf16 v[84:87], v[88:91], v[10:13], 0
    v_mfma_f32_16x16x32_bf16 v[88:91], v[92:95], v[10:13], 0
    v_mfma_f32_16x16x32_bf16 v[92:95], v[96:99], v[10:13], 0
    v_mov_b32_dpp v64, v64 quad_perm:[0,0,0,0] row_mask:0xf bank_mask:0xf
    v_mov_b32_dpp v68, v68 quad_perm:[0,0,0,0] row_mask:0xf bank_mask:0xf
    v_mov_b32_dpp v72, v72 quad_perm:[0,0,0,0] row_mask:0xf bank_mask:0xf
    v_mov_b32_dpp v76, v76 quad_perm:[0,0,0,0] row_mask:0xf bank_mask:0xf
    v_add_f32_dpp v64, v65, v64 quad_perm:[1,1,1,1] row_mask:0xf bank_mask:0xf
    v_add_f32_dpp v68, v69, v68 quad_perm:[1,1,1,1] row_mask:0xf bank_mask:0xf
    v_add_f32_dpp v72, v73, v72 quad_perm:[1,1,1,1] row_mask:0xf bank_mask:0xf
    v_add_f32_dpp v76, v77, v76 quad_perm:[1,1,1,1] row_mask:0xf bank_mask:0xf
    v_add_f32_dpp v64, v66, v64 quad_perm:[2,2,2,2] row_mask:0xf bank_mask:0xf
    v_add_f32_dpp v68, v70, v68 quad_perm:[2,2,2,2] row_mask:0xf bank_mask:0xf
    v_add_f32_dpp v72, v74, v72 quad_perm:[2,2,2,2] row_mask:0xf bank_mask:0xf
    v_add_f32_dpp v76, v78, v76 quad_perm:[2,2,2,2] row_mask:0xf bank_mask:0xf
    v_add_f32_dpp v64, v67, v64 quad_perm:[3,3,3,3] row_mask:0xf bank_mask:0xf
    v_add_f32_dpp v68, v71, v68 quad_perm:[3,3,3,3] row_mask:0xf bank_mask:0xf
    v_add_f32_dpp v72, v75, v72 quad_perm:[3,3,3,3] row_mask:0xf bank_mask:0xf
    v_add_f32_dpp v76, v79, v76 quad_perm:[3,3,3,3] row_mask:0xf bank_mask:0xf
    v_max3_f32 v23, v23, v64, v68
    v_max3_f32 v23, v23, v72, v76
    s_waitcnt vmcnt(11)
    v_mfma_f32_16x16x32_bf16 v[96:99], v[100:103], v[10:13], 0
    v_mov_b32_dpp v80, v80 quad_perm:[0,0,0,0] row_mask:0xf bank_mask:0xf
    v_mov_b32_dpp v84, v84 quad_perm:[0,0,0,0] row_mask:0xf bank_mask:0xf
    v_mov_b32_dpp v88, v88 quad_perm:[0,0,0,0] row_mask:0xf bank_mask:0xf
    v_mov_b32_dpp v92, v92 quad_perm:[0,0,0,0] row_mask:0xf bank_mask:0xf
    v_add_f32_dpp v80, v81, v80 quad_perm:[1,1,1,1] row_mask:0xf bank_mask:0xf
    v_add_f32_dpp v84, v85, v84 quad_perm:[1,1,1,1] row_mask:0xf bank_mask:0xf
    v_add_f32_dpp v88, v89, v88 quad_perm:[1,1,1,1] row_mask:0xf bank_mask:0xf
    v_add_f32_dpp v92, v93, v92 quad_perm:[1,1,1,1] row_mask:0xf bank_mask:0xf
    v_add_f32_dpp v80, v82, v80 quad_perm:[2,2,2,2] row_mask:0xf bank_mask:0xf
    v_add_f32_dpp v84, v86, v84 quad_perm:[2,2,2,2] row_mask:0xf bank_mask:0xf
    v_add_f32_dpp v88, v90, v88 quad_perm:[2,2,2,2] row_mask:0xf bank_mask:0xf
    v_add_f32_dpp v92, v94, v92 quad_perm:[2,2,2,2] row_mask:0xf bank_mask:0xf
    v_add_f32_dpp v80, v83, v80 quad_perm:[3,3,3,3] row_mask:0xf bank_mask:0xf
    v_add_f32_dpp v84, v87, v84 quad_perm:[3,3,3,3] row_mask:0xf bank_mask:0xf
    v_add_f32_dpp v88, v91, v88 quad_perm:[3,3,3,3] row_mask:0xf bank_mask:0xf
    v_add_f32_dpp v92, v95, v92 quad_perm:[3,3,3,3] row_mask:0xf bank_mask:0xf
    v_max3_f32 v23, v23, v80, v84
    v_max3_f32 v23, v23, v88, v92
    v_mov_b32_dpp v96, v96 quad_perm:[0,0,0,0] row_mask:0xf bank_mask:0xf
    s_nop 1
    v_add_f32_dpp v96, v97, v96 quad_perm:[1,1,1,1] row_mask:0xf bank_mask:0xf
    s_nop 1
    v_add_f32_dpp v96, v98, v96 quad_perm:[2,2,2,2] row_mask:0xf bank_mask:0xf
    s_nop 1
    v_add_f32_dpp v96, v99, v96 quad_perm:[3,3,3,3] row_mask:0xf bank_mask:0xf
    v_max_f32 v23, v23, v96
    v_mov_b32 v3, v23
    s_nop 1
    v_permlane16_swap_b32 v23, v3
    v_max_f32 v23, v23, v3
    v_mov_b32 v3, v23
    s_nop 1
    v_permlane32_swap_b32 v23, v3
    v_max_f32 v23, v23, v3
    v_mul_f32 v23, s15, v23
    ds_write_b32 v30, v23 offset:9216
    v_fma_f32 v32, v32, s15, -v23
    v_fma_f32 v36, v36, s15, -v23
    v_fma_f32 v40, v40, s15, -v23
    v_fma_f32 v44, v44, s15, -v23
    v_fma_f32 v48, v48, s15, -v23
    v_fma_f32 v52, v52, s15, -v23
    v_fma_f32 v56, v56, s15, -v23
    v_fma_f32 v60, v60, s15, -v23
    v_fma_f32 v64, v64, s15, -v23
    v_fma_f32 v68, v68, s15, -v23
    v_fma_f32 v72, v72, s15, -v23
    v_fma_f32 v76, v76, s15, -v23
    v_fma_f32 v80, v80, s15, -v23
    v_fma_f32 v84, v84, s15, -v23
    v_fma_f32 v88, v88, s15, -v23
    v_fma_f32 v92, v92, s15, -v23
    v_fma_f32 v96, v96, s15, -v23
    v_exp_f32 v32, v32
    v_exp_f32 v36, v36
    v_exp_f32 v40, v40
    v_exp_f32 v44, v44
    v_exp_f32 v48, v48
    v_exp_f32 v52, v52
    v_exp_f32 v56, v56
    v_exp_f32 v60, v60
    v_exp_f32 v64, v64
    v_exp_f32 v68, v68
    v_exp_f32 v72, v72
    v_exp_f32 v76, v76
    v_exp_f32 v80, v80
    v_exp_f32 v84, v84
    v_exp_f32 v88, v88
    v_exp_f32 v92, v92
    v_exp_f32 v96, v96
    v_add_f32 v22, v32, v36
    v_add_f32 v22, v22, v40
    v_add_f32 v22, v22, v44
    v_add_f32 v22, v22, v48
    v_add_f32 v22, v22, v52
    v_add_f32 v22, v22, v56
    v_add_f32 v22, v22, v60
    v_add_f32 v22, v22, v64
    v_add_f32 v22, v22, v68
    v_add_f32 v22, v22, v72
    v_add_f32 v22, v22, v76
    v_add_f32 v22, v22, v80
    v_add_f32 v22, v22, v84
    v_add_f32 v22, v22, v88
    v_add_f32 v22, v22, v92
    v_add_f32 v22, v22, v96
    v_cvt_pk_bf16_f32 v32, v32, v36
    v_cvt_pk_bf16_f32 v40, v40, v44
    v_cvt_pk_bf16_f32 v48, v48, v52
    v_cvt_pk_bf16_f32 v56, v56, v60
    v_cvt_pk_bf16_f32 v64, v64, v68
    v_cvt_pk_bf16_f32 v72, v72, v76
    v_cvt_pk_bf16_f32 v80, v80, v84
    v_cvt_pk_bf16_f32 v88, v88, v92
    v_cvt_pk_bf16_f32 v96, v96, v96
    v_mov_b32 v3, v22
    s_nop 1
    v_permlane16_swap_b32 v22, v3
    v_add_f32 v22, v22, v3
    v_mov_b32 v3, v22
    s_nop 1
    v_permlane32_swap_b32 v22, v3
    v_add_f32 v22, v22, v3
    ds_write_b32 v30, v22 offset:9344
    v_mov_b32 v24, 0
    v_mov_b32 v25, 1
    s_mov_b64 exec, 1
    ds_add_rtn_u32 v26, v24, v25 offset:9476
    s_waitcnt lgkmcnt(0)
    v_cmp_eq_u32 vcc, 7, v26
    s_mov_b64 exec, -1
    s_cbranch_vccz L_skip_27
    v_and_b32 v24, 3, v0
    v_lshlrev_b32 v24, 5, v24
    ds_read_b128 v[246:249], v24 offset:9216
    ds_read_b128 v[250:253], v24 offset:9232
    ds_read_b128 v[10:13], v24 offset:9344
    ds_read_b128 v[14:17], v24 offset:9360
    v_mov_b32 v27, s95
    s_lshl_b32 s10, s8, 3
    s_add_u32 s10, s10, s7
    s_mul_i32 s10, s10, 12
    s_add_u32 s10, s10, s9
    s_lshl_b32 s10, s10, 6
    s_add_u32 s10, s10, 294912
    s_mov_b32 s11, 0xffffff00
    s_waitcnt lgkmcnt(0)
    v_max3_f32 v26, v246, v247, v248
    v_max3_f32 v26, v26, v249, v250
    v_max3_f32 v26, v26, v251, v252
    v_max_f32 v26, v26, v253
    v_sub_f32 v246, v246, v26
    v_sub_f32 v247, v247, v26
    v_sub_f32 v248, v248, v26
    v_sub_f32 v249, v249, v26
    v_sub_f32 v250, v250, v26
    v_sub_f32 v251, v251, v26
    v_sub_f32 v252, v252, v26
    v_sub_f32 v253, v253, v26
    v_exp_f32 v246, v246
    v_exp_f32 v247, v247
    v_exp_f32 v248, v248
    v_exp_f32 v249, v249
    v_exp_f32 v250, v250
    v_exp_f32 v251, v251
    v_exp_f32 v252, v252
    v_exp_f32 v253, v253
    v_mul_f32 v25, v246, v10
    v_fmac_f32 v25, v247, v11
    v_fmac_f32 v25, v248, v12
    v_fmac_f32 v25, v249, v13
    v_fmac_f32 v25, v250, v14
    v_fmac_f32 v25, v251, v15
    v_fmac_f32 v25, v252, v16
    v_fmac_f32 v25, v253, v17
    v_bfi_b32 v248, s11, v25, v27
    v_bfi_b32 v246, s11, v26, v27
    v_mov_b32 v247, s94
    v_mov_b32 v249, s94
    s_mov_b64 exec, 15
    buffer_store_dwordx4 v[246:249], v2, s[44:47], s10 offen sc1
    s_mov_b64 exec, -1
L_skip_27:
    v_perm_b32 v230, v32, v32, v4
    v_perm_b32 v231, v32, v32, v5
    v_perm_b32 v234, v32, v32, v6
    v_perm_b32 v235, v32, v32, v7
    v_perm_b32 v238, v40, v40, v4
    v_perm_b32 v239, v40, v40, v5
    v_perm_b32 v242, v40, v40, v6
    v_perm_b32 v243, v40, v40, v7
    s_waitcnt vmcnt(10)
    v_mfma_f32_16x16x32_bf16 v[14:17], v[230:233], v[132:135], 0
    v_mfma_f32_16x16x32_bf16 v[18:21], v[228:231], v[132:135], 0
    s_waitcnt vmcnt(9)
    v_mfma_f32_16x16x32_bf16 v[14:17], v[234:237], v[136:139], v[14:17]
    v_mfma_f32_16x16x32_bf16 v[18:21], v[232:235], v[136:139], v[18:21]
    s_waitcnt vmcnt(8)
    v_mfma_f32_16x16x32_bf16 v[14:17], v[238:241], v[140:143], v[14:17]
    v_mfma_f32_16x16x32_bf16 v[18:21], v[236:239], v[140:143], v[18:21]
    s_waitcnt vmcnt(7)
    v_mfma_f32_16x16x32_bf16 v[14:17], v[242:245], v[144:147], v[14:17]
    v_mfma_f32_16x16x32_bf16 v[18:21], v[240:243], v[144:147], v[18:21]
    v_perm_b32 v230, v48, v48, v4
    v_perm_b32 v231, v48, v48, v5
    v_perm_b32 v234, v48, v48, v6
    v_perm_b32 v235, v48, v48, v7
    v_perm_b32 v238, v56, v56, v4
    v_perm_b32 v239, v56, v56, v5
    v_perm_b32 v242, v56, v56, v6
    v_perm_b32 v243, v56, v56, v7
    s_waitcnt vmcnt(6)
    v_mfma_f32_16x16x32_bf16 v[14:17], v[230:233], v[148:151], v[14:17]
    v_mfma_f32_16x16x32_bf16 v[18:21], v[228:231], v[148:151], v[18:21]
    s_waitcnt vmcnt(5)
    v_mfma_f32_16x16x32_bf16 v[14:17], v[234:237], v[152:155], v[14:17]
    v_mfma_f32_16x16x32_bf16 v[18:21], v[232:235], v[152:155], v[18:21]
    s_waitcnt vmcnt(4)
    v_mfma_f32_16x16x32_bf16 v[14:17], v[238:241], v[156:159], v[14:17]
    v_mfma_f32_16x16x32_bf16 v[18:21], v[236:239], v[156:159], v[18:21]
    s_waitcnt vmcnt(3)
    buffer_load_dwordx4 v[176:179], v2, s[52:55], s6 offen offset:0 nt
    s_add_u32 s6, s6, 8192
    v_mfma_f32_16x16x32_bf16 v[14:17], v[242:245], v[160:163], v[14:17]
    v_mfma_f32_16x16x32_bf16 v[18:21], v[240:243], v[160:163], v[18:21]
    v_perm_b32 v230, v64, v64, v4
    v_perm_b32 v231, v64, v64, v5
    v_perm_b32 v234, v64, v64, v6
    v_perm_b32 v235, v64, v64, v7
    v_perm_b32 v238, v72, v72, v4
    v_perm_b32 v239, v72, v72, v5
    v_perm_b32 v242, v72, v72, v6
    v_perm_b32 v243, v72, v72, v7
    s_waitcnt vmcnt(3)
    buffer_load_dwordx4 v[180:183], v2, s[52:55], s6 offen offset:0 nt
    s_add_u32 s6, s6, 8192
    v_mfma_f32_16x16x32_bf16 v[14:17], v[230:233], v[164:167], v[14:17]
    v_mfma_f32_16x16x32_bf16 v[18:21], v[228:231], v[164:167], v[18:21]
    s_waitcnt vmcnt(3)
    buffer_load_dwordx4 v[184:187], v2, s[52:55], s6 offen offset:0 nt
    s_add_u32 s6, s6, 8192
    v_mfma_f32_16x16x32_bf16 v[14:17], v[234:237], v[168:171], v[14:17]
    v_mfma_f32_16x16x32_bf16 v[18:21], v[232:235], v[168:171], v[18:21]
    s_waitcnt vmcnt(3)
    buffer_load_dwordx4 v[188:191], v2, s[52:55], s6 offen offset:0 nt
    s_add_u32 s6, s6, 8192
    v_mfma_f32_16x16x32_bf16 v[14:17], v[238:241], v[172:175], v[14:17]
    v_mfma_f32_16x16x32_bf16 v[18:21], v[236:239], v[172:175], v[18:21]
    s_waitcnt vmcnt(3)
    buffer_load_dwordx4 v[192:195], v2, s[52:55], s6 offen offset:0 nt
    s_add_u32 s6, s6, 8192
    v_mfma_f32_16x16x32_bf16 v[14:17], v[242:245], v[176:179], v[14:17]
    v_mfma_f32_16x16x32_bf16 v[18:21], v[240:243], v[176:179], v[18:21]
    v_perm_b32 v230, v80, v80, v4
    v_perm_b32 v231, v80, v80, v5
    v_perm_b32 v234, v80, v80, v6
    v_perm_b32 v235, v80, v80, v7
    v_perm_b32 v238, v88, v88, v4
    v_perm_b32 v239, v88, v88, v5
    v_perm_b32 v242, v88, v88, v6
    v_perm_b32 v243, v88, v88, v7
    s_waitcnt vmcnt(3)
    buffer_load_dwordx4 v[196:199], v2, s[52:55], s6 offen offset:0 nt
    v_mfma_f32_16x16x32_bf16 v[14:17], v[230:233], v[180:183], v[14:17]
    v_mfma_f32_16x16x32_bf16 v[18:21], v[228:231], v[180:183], v[18:21]
    s_waitcnt vmcnt(3)
    v_mfma_f32_16x16x32_bf16 v[14:17], v[234:237], v[184:187], v[14:17]
    v_mfma_f32_16x16x32_bf16 v[18:21], v[232:235], v[184:187], v[18:21]
    s_waitcnt vmcnt(2)
    v_mfma_f32_16x16x32_bf16 v[14:17], v[238:241], v[188:191], v[14:17]
    v_mfma_f32_16x16x32_bf16 v[18:21], v[236:239], v[188:191], v[18:21]
    s_waitcnt vmcnt(1)
    v_mfma_f32_16x16x32_bf16 v[14:17], v[242:245], v[192:195], v[14:17]
    v_mfma_f32_16x16x32_bf16 v[18:21], v[240:243], v[192:195], v[18:21]
    v_perm_b32 v230, v96, v96, v4
    v_perm_b32 v231, v96, v96, v5
    v_mov_b32 v24, 0
    v_lshrrev_b32 v25, 4, v0
    v_lshlrev_b32 v25, 5, v25
    s_lshl_b32 s10, s3, 2
    v_add_u32 v26, s10, v25
L_spin_28:
    ds_read_b32 v27, v24 offset:9476
    ds_read_b128 v[246:249], v25 offset:9216
    ds_read_b128 v[250:253], v25 offset:9232
    ds_read_b32 v22, v26 offset:9216
    s_waitcnt lgkmcnt(0)
    v_cmp_ne_u32 vcc, 8, v27
    s_cbranch_vccz L_ok_29
    s_sleep 1
    s_sub_u32 s14, s14, 1
    s_cbranch_scc0 L_spin_28
L_ok_29:
    v_max3_f32 v23, v246, v247, v248
    v_max3_f32 v23, v23, v249, v250
    v_max3_f32 v23, v23, v251, v252
    v_max_f32 v23, v23, v253
    v_sub_f32 v22, v22, v23
    v_exp_f32 v22, v22
    s_lshl_b32 s10, s3, 11
    v_lshl_add_u32 v24, v0, 5, s10
    s_lshl_b32 s10, s3, 8
    v_and_b32 v26, 31, v0
    v_lshl_add_u32 v25, v26, 3, s10
    v_lshlrev_b32 v26, 2, v0
    s_lshl_b32 s10, s7, 2
    s_lshr_b32 s11, s3, 1
    s_add_u32 s10, s10, s11
    s_lshl_b32 s10, s10, 15
    s_mul_i32 s11, s8, 24
    s_add_u32 s11, s11, s9
    s_add_u32 s11, s11, s9
    s_and_b32 s12, s3, 1
    s_add_u32 s11, s11, s12
    s_lshl_b32 s11, s11, 7
    s_add_u32 s10, s10, s11
    s_add_u32 s10, s10, 1048576
    s_waitcnt vmcnt(0)
    v_mfma_f32_16x16x32_bf16 v[14:17], v[230:233], v[196:199], v[14:17]
    v_mfma_f32_16x16x32_bf16 v[18:21], v[228:231], v[196:199], v[18:21]
    s_nop 6
    v_mul_f32 v14, v14, v22
    v_mul_f32 v15, v15, v22
    v_mul_f32 v16, v16, v22
    v_mul_f32 v17, v17, v22
    v_mul_f32 v18, v18, v22
    v_mul_f32 v19, v19, v22
    v_mul_f32 v20, v20, v22
    v_mul_f32 v21, v21, v22
    ds_write_b128 v24, v[14:17] offset:16384
    ds_write_b128 v24, v[18:21] offset:16400
    s_waitcnt lgkmcnt(0)
    s_barrier
    ds_read_b64 v[36:37], v25 offset:16384
    ds_read_b64 v[38:39], v25 offset:18432
    ds_read_b64 v[40:41], v25 offset:20480
    ds_read_b64 v[42:43], v25 offset:22528
    ds_read_b64 v[44:45], v25 offset:24576
    ds_read_b64 v[46:47], v25 offset:26624
    ds_read_b64 v[48:49], v25 offset:28672
    ds_read_b64 v[50:51], v25 offset:30720
    s_waitcnt lgkmcnt(6)
    v_add_f32 v36, v36, v38
    v_add_f32 v37, v37, v39
    s_waitcnt lgkmcnt(4)
    v_add_f32 v40, v40, v42
    v_add_f32 v41, v41, v43
    v_add_f32 v36, v36, v40
    v_add_f32 v37, v37, v41
    s_waitcnt lgkmcnt(2)
    v_add_f32 v44, v44, v46
    v_add_f32 v45, v45, v47
    v_add_f32 v36, v36, v44
    v_add_f32 v37, v37, v45
    s_waitcnt lgkmcnt(0)
    v_add_f32 v48, v48, v50
    v_add_f32 v49, v49, v51
    v_add_f32 v36, v36, v48
    v_add_f32 v37, v37, v49
    v_cvt_pk_bf16_f32 v36, v36, v37
    v_min_u32 v36, -2, v36
    s_mov_b32 exec_hi, 0
    buffer_store_dword v36, v26, s[44:47], s10 offen sc1
    s_mov_b64 exec, -1
    s_mov_b32 s4, s68
    s_cmp_lt_u32 s3, 4
    s_cbranch_scc1 L_ATAIL
    s_endpgm
L_Q_B:
    s_waitcnt vmcnt(4)
    buffer_load_dwordx4 v[36:39], v1, s[48:51], s5 offen offset:0 nt
    s_add_u32 s5, s5, 8192
    s_waitcnt vmcnt(4)
    buffer_load_dwordx4 v[40:43], v1, s[48:51], s5 offen offset:0 nt
    s_add_u32 s5, s5, 8192
    s_waitcnt vmcnt(4)
    buffer_load_dwordx4 v[44:47], v1, s[48:51], s5 offen offset:0 nt
    s_add_u32 s5, s5, 8192
    s_waitcnt vmcnt(4)
    buffer_load_dwordx4 v[48:51], v1, s[48:51], s5 offen offset:0 nt
    s_add_u32 s5, s5, 8192
    s_waitcnt vmcnt(4)
    buffer_load_dwordx4 v[52:55], v1, s[48:51], s5 offen offset:0 nt
    s_add_u32 s5, s5, 8192
    s_waitcnt vmcnt(4)
    buffer_load_dwordx4 v[56:59], v1, s[48:51], s5 offen offset:0 nt
    s_add_u32 s5, s5, 8192
    s_waitcnt vmcnt(4)
    buffer_load_dwordx4 v[60:63], v1, s[48:51], s5 offen offset:0 nt
    s_add_u32 s5, s5, 8192
    s_cmp_eq_u32 s3, 0
    s_cselect_b32 s13, 0, 0x40000000
    s_lshl_b32 s12, s7, 7
    s_add_u32 s12, s12, 327680
    s_add_u32 s12, s12, s13
    v_lshlrev_b32 v26, 3, v0
    s_mov_b64 exec, 0xffff
    buffer_load_dwordx2 v[24:25], v26, s[44:47], s12 offen sc1
    s_mov_b64 exec, -1
    s_waitcnt vmcnt(5)
    s_waitcnt vmcnt(4)
    buffer_load_dwordx4 v[64:67], v1, s[48:51], s5 offen offset:0 nt
    s_add_u32 s5, s5, 8192
    s_waitcnt vmcnt(4)
    buffer_load_dwordx4 v[68:71], v1, s[48:51], s5 offen offset:0 nt
    s_add_u32 s5, s5, 8192
    s_waitcnt vmcnt(4)
    buffer_load_dwordx4 v[72:75], v1, s[48:51], s5 offen offset:0 nt
    s_add_u32 s5, s5, 8192
    s_waitcnt vmcnt(4)
    buffer_load_dwordx4 v[76:79], v1, s[48:51], s5 offen offset:0 nt
    s_add_u32 s5, s5, 8192
    s_lshl_b32 s10, s8, 14
    s_lshl_b32 s11, s7, 11
    s_add_u32 s10, s10, s11
    s_add_u32 s10, s10, 0
    s_add_u32 s10, s10, s13
    s_add_u32 s11, s10, 32768
    v_lshlrev_b32 v3, 5, v0
    s_waitcnt vmcnt(4)
    s_cmp_lg_u32 s3, 0
    s_cbranch_scc1 L_ok_31
    s_mov_b64 exec, 0xffff
L_spin_30:
    v_cmp_ne_u64 vcc, s[94:95], v[24:25]
    s_cbranch_vccz L_ok_31
    buffer_load_dwordx2 v[24:25], v26, s[44:47], s12 offen sc1
    s_waitcnt vmcnt(0)
    s_sub_u32 s14, s14, 1
    s_cbranch_scc0 L_spin_30
L_ok_31:
    s_mov_b64 exec, -1
    buffer_load_dwordx4 v[228:231], v3, s[44:47], s10 offen offset:0 sc1
    buffer_load_dwordx4 v[232:235], v3, s[44:47], s10 offen offset:16 sc1
    buffer_load_dwordx4 v[236:239], v3, s[44:47], s11 offen offset:0 sc1
    buffer_load_dwordx4 v[240:243], v3, s[44:47], s11 offen offset:16 sc1
    s_waitcnt vmcnt(7)
    buffer_load_dwordx4 v[80:83], v1, s[48:51], s5 offen offset:0 nt
    s_add_u32 s5, s5, 8192
    s_waitcnt vmcnt(7)
    buffer_load_dwordx4 v[84:87], v1, s[48:51], s5 offen offset:0 nt
    s_waitcnt vmcnt(7)
    buffer_load_dwordx4 v[132:135], v2, s[52:55], s6 offen offset:0 nt
    s_add_u32 s6, s6, 8192
    s_waitcnt vmcnt(7)
    buffer_load_dwordx4 v[136:139], v2, s[52:55], s6 offen offset:0 nt
    s_add_u32 s6, s6, 8192
    s_cmp_lg_u32 s3, 0
    s_cbranch_scc1 L_skip_32
    s_waitcnt vmcnt(4)
    v_add_f32 v228, v228, v236
    v_add_f32 v229, v229, v237
    v_add_f32 v230, v230, v238
    v_add_f32 v231, v231, v239
    v_add_f32 v232, v232, v240
    v_add_f32 v233, v233, v241
    v_add_f32 v234, v234, v242
    v_add_f32 v235, v235, v243
    v_cvt_pk_bf16_f32 v228, v228, v229
    v_cvt_pk_bf16_f32 v229, v230, v231
    v_cvt_pk_bf16_f32 v230, v232, v233
    v_cvt_pk_bf16_f32 v231, v234, v235
    v_mov_b32 v24, 0
    v_mov_b32 v25, 1
    ds_write_b128 v2, v[228:231] offset:8192
    s_waitcnt lgkmcnt(0)
    ds_write_b32 v24, v25 offset:9472
L_skip_32:
    s_waitcnt vmcnt(3)
    buffer_load_dwordx4 v[140:143], v2, s[52:55], s6 offen offset:0 nt
    s_add_u32 s6, s6, 8192
    s_waitcnt vmcnt(3)
    buffer_load_dwordx4 v[144:147], v2, s[52:55], s6 offen offset:0 nt
    s_add_u32 s6, s6, 8192
    v_mov_b32 v24, 0
    s_mov_b32 s14, 400000
L_spin_33:
    ds_read_b32 v25, v24 offset:9472
    ds_read_b128 v[10:13], v1 offset:8192
    s_waitcnt lgkmcnt(0)
    v_cmp_eq_u32 vcc, 0, v25
    s_cbranch_vccz L_ok_34
    s_sleep 1
    s_sub_u32 s14, s14, 1
    s_cbranch_scc0 L_spin_33
L_ok_34:
    v_bfe_u32 v29, v0, 2, 2
    v_lshlrev_b32 v29, 5, v29
    s_lshl_b32 s10, s3, 2
    v_add_u32 v30, s10, v29
    v_mov_b32 v228, 0
    v_mov_b32 v229, 0
    v_mov_b32 v232, 0
    v_mov_b32 v233, 0
    v_mov_b32 v236, 0
    v_mov_b32 v237, 0
    v_mov_b32 v240, 0
    v_mov_b32 v241, 0
    v_mov_b32 v244, 0
    v_mov_b32 v245, 0
    buffer_load_dwordx4 v[148:151], v2, s[52:55], s6 offen offset:0 nt
    s_add_u32 s6, s6, 8192
    buffer_load_dwordx4 v[152:155], v2, s[52:55], s6 offen offset:0 nt
    s_add_u32 s6, s6, 8192
    v_mfma_f32_16x16x32_bf16 v[32:35], v[36:39], v[10:13], 0
    v_mfma_f32_16x16x32_bf16 v[36:39], v[40:43], v[10:13], 0
    v_mfma_f32_16x16x32_bf16 v[40:43], v[44:47], v[10:13], 0
    v_mfma_f32_16x16x32_bf16 v[44:47], v[48:51], v[10:13], 0
    buffer_load_dwordx4 v[156:159], v2, s[52:55], s6 offen offset:0 nt
    s_add_u32 s6, s6, 8192
    buffer_load_dwordx4 v[160:163], v2, s[52:55], s6 offen offset:0 nt
    s_add_u32 s6, s6, 8192
    v_mfma_f32_16x16x32_bf16 v[48:51], v[52:55], v[10:13], 0
    v_mfma_f32_16x16x32_bf16 v[52:55], v[56:59], v[10:13], 0
    v_mfma_f32_16x16x32_bf16 v[56:59], v[60:63], v[10:13], 0
    v_mfma_f32_16x16x32_bf16 v[60:63], v[64:67], v[10:13], 0
    v_mov_b32_dpp v32, v32 quad_perm:[0,0,0,0] row_mask:0xf bank_mask:0xf
    v_mov_b32_dpp v36, v36 quad_perm:[0,0,0,0] row_mask:0xf bank_mask:0xf
    v_mov_b32_dpp v40, v40 quad_perm:[0,0,0,0] row_mask:0xf bank_mask:0xf
    v_mov_b32_dpp v44, v44 quad_perm:[0,0,0,0] row_mask:0xf bank_mask:0xf
    v_add_f32_dpp v32, v33, v32 quad_perm:[1,1,1,1] row_mask:0xf bank_mask:0xf
    v_add_f32_dpp v36, v37, v36 quad_perm:[1,1,1,1] row_mask:0xf bank_mask:0xf
    v_add_f32_dpp v40, v41, v40 quad_perm:[1,1,1,1] row_mask:0xf bank_mask:0xf
    v_add_f32_dpp v44, v45, v44 quad_perm:[1,1,1,1] row_mask:0xf bank_mask:0xf
    v_add_f32_dpp v32, v34, v32 quad_perm:[2,2,2,2] row_mask:0xf bank_mask:0xf
    v_add_f32_dpp v36, v38, v36 quad_perm:[2,2,2,2] row_mask:0xf bank_mask:0xf
    v_add_f32_dpp v40, v42, v40 quad_perm:[2,2,2,2] row_mask:0xf bank_mask:0xf
    v_add_f32_dpp v44, v46, v44 quad_perm:[2,2,2,2] row_mask:0xf bank_mask:0xf
    v_add_f32_dpp v32, v35, v32 quad_perm:[3,3,3,3] row_mask:0xf bank_mask:0xf
    v_add_f32_dpp v36, v39, v36 quad_perm:[3,3,3,3] row_mask:0xf bank_mask:0xf
    v_add_f32_dpp v40, v43, v40 quad_perm:[3,3,3,3] row_mask:0xf bank_mask:0xf
    v_add_f32_dpp v44, v47, v44 quad_perm:[3,3,3,3] row_mask:0xf bank_mask:0xf
    v_max3_f32 v23, v32, v36, v40
    v_max_f32 v23, v23, v44
    buffer_load_dwordx4 v[164:167], v2, s[52:55], s6 offen offset:0 nt
    s_add_u32 s6, s6, 8192
    buffer_load_dwordx4 v[168:171], v2, s[52:55], s6 offen offset:0 nt
    s_add_u32 s6, s6, 8192
    v_mfma_f32_16x16x32_bf16 v[64:67], v[68:71], v[10:13], 0
    v_mfma_f32_16x16x32_bf16 v[68:71], v[72:75], v[10:13], 0
    v_mfma_f32_16x16x32_bf16 v[72:75], v[76:79], v[10:13], 0
    v_mfma_f32_16x16x32_bf16 v[76:79], v[80:83], v[10:13], 0
    v_mov_b32_dpp v48, v48 quad_perm:[0,0,0,0] row_mask:0xf bank_mask:0xf
    v_mov_b32_dpp v52, v52 quad_perm:[0,0,0,0] row_mask:0xf bank_mask:0xf
    v_mov_b32_dpp v56, v56 quad_perm:[0,0,0,0] row_mask:0xf bank_mask:0xf
    v_mov_b32_dpp v60, v60 quad_perm:[0,0,0,0] row_mask:0xf bank_mask:0xf
    v_add_f32_dpp v48, v49, v48 quad_perm:[1,1,1,1] row_mask:0xf bank_mask:0xf
    v_add_f32_dpp v52, v53, v52 quad_perm:[1,1,1,1] row_mask:0xf bank_mask:0xf
    v_add_f32_dpp v56, v57, v56 quad_perm:[1,1,1,1] row_mask:0xf bank_mask:0xf
    v_add_f32_dpp v60, v61, v60 quad_perm:[1,1,1,1] row_mask:0xf bank_mask:0xf
    v_add_f32_dpp v48, v50, v48 quad_perm:[2,2,2,2] row_mask:0xf bank_mask:0xf
    v_add_f32_dpp v52, v54, v52 quad_perm:[2,2,2,2] row_mask:0xf bank_mask:0xf
    v_add_f32_dpp v56, v58, v56 quad_perm:[2,2,2,2] row_mask:0xf bank_mask:0xf
    v_add_f32_dpp v60, v62, v60 quad_perm:[2,2,2,2] row_mask:0xf bank_mask:0xf
    v_add_f32_dpp v48, v51, v48 quad_perm:[3,3,3,3] row_mask:0xf bank_mask:0xf
    v_add_f32_dpp v52, v55, v52 quad_perm:[3,3,3,3] row_mask:0xf bank_mask:0xf
    v_add_f32_dpp v56, v59, v56 quad_perm:[3,3,3,3] row_mask:0xf bank_mask:0xf
    v_add_f32_dpp v60, v63, v60 quad_perm:[3,3,3,3] row_mask:0xf bank_mask:0xf
    v_max3_f32 v23, v23, v48, v52
    v_max3_f32 v23, v23, v56, v60
    buffer_load_dwordx4 v[172:175], v2, s[52:55], s6 offen offset:0 nt
    s_add_u32 s6, s6, 8192
    buffer_load_dwordx4 v[176:179], v2, s[52:55], s6 offen offset:0 nt
    s_add_u32 s6, s6, 8192
    v_mfma_f32_16x16x32_bf16 v[80:83], v[84:87], v[10:13], 0
    v_mov_b32_dpp v64, v64 quad_perm:[0,0,0,0] row_mask:0xf bank_mask:0xf
    v_mov_b32_dpp v68, v68 quad_perm:[0,0,0,0] row_mask:0xf bank_mask:0xf
    v_mov_b32_dpp v72, v72 quad_perm:[0,0,0,0] row_mask:0xf bank_mask:0xf
    v_mov_b32_dpp v76, v76 quad_perm:[0,0,0,0] row_mask:0xf bank_mask:0xf
    v_add_f32_dpp v64, v65, v64 quad_perm:[1,1,1,1] row_mask:0xf bank_mask:0xf
    v_add_f32_dpp v68, v69, v68 quad_perm:[1,1,1,1] row_mask:0xf bank_mask:0xf
    v_add_f32_dpp v72, v73, v72 quad_perm:[1,1,1,1] row_mask:0xf bank_mask:0xf
    v_add_f32_dpp v76, v77, v76 quad_perm:[1,1,1,1] row_mask:0xf bank_mask:0xf
    v_add_f32_dpp v64, v66, v64 quad_perm:[2,2,2,2] row_mask:0xf bank_mask:0xf
    v_add_f32_dpp v68, v70, v68 quad_perm:[2,2,2,2] row_mask:0xf bank_mask:0xf
    v_add_f32_dpp v72, v74, v72 quad_perm:[2,2,2,2] row_mask:0xf bank_mask:0xf
    v_add_f32_dpp v76, v78, v76 quad_perm:[2,2,2,2] row_mask:0xf bank_mask:0xf
    v_add_f32_dpp v64, v67, v64 quad_perm:[3,3,3,3] row_mask:0xf bank_mask:0xf
    v_add_f32_dpp v68, v71, v68 quad_perm:[3,3,3,3] row_mask:0xf bank_mask:0xf
    v_add_f32_dpp v72, v75, v72 quad_perm:[3,3,3,3] row_mask:0xf bank_mask:0xf
    v_add_f32_dpp v76, v79, v76 quad_perm:[3,3,3,3] row_mask:0xf bank_mask:0xf
    v_max3_f32 v23, v23, v64, v68
    v_max3_f32 v23, v23, v72, v76
    v_mov_b32_dpp v80, v80 quad_perm:[0,0,0,0] row_mask:0xf bank_mask:0xf
    s_nop 1
    v_add_f32_dpp v80, v81, v80 quad_perm:[1,1,1,1] row_mask:0xf bank_mask:0xf
    s_nop 1
    v_add_f32_dpp v80, v82, v80 quad_perm:[2,2,2,2] row_mask:0xf bank_mask:0xf
    s_nop 1
    v_add_f32_dpp v80, v83, v80 quad_perm:[3,3,3,3] row_mask:0xf bank_mask:0xf
    v_max_f32 v23, v23, v80
    v_mov_b32 v3, v23
    s_nop 1
    v_permlane16_swap_b32 v23, v3
    v_max_f32 v23, v23, v3
    v_mov_b32 v3, v23
    s_nop 1
    v_permlane32_swap_b32 v23, v3
    v_max_f32 v23, v23, v3
    v_mul_f32 v23, s15, v23
    ds_write_b32 v30, v23 offset:9216
    v_fma_f32 v32, v32, s15, -v23
    v_fma_f32 v36, v36, s15, -v23
    v_fma_f32 v40, v40, s15, -v23
    v_fma_f32 v44, v44, s15, -v23
    v_fma_f32 v48, v48, s15, -v23
    v_fma_f32 v52, v52, s15, -v23
    v_fma_f32 v56, v56, s15, -v23
    v_fma_f32 v60, v60, s15, -v23
    v_fma_f32 v64, v64, s15, -v23
    v_fma_f32 v68, v68, s15, -v23
    v_fma_f32 v72, v72, s15, -v23
    v_fma_f32 v76, v76, s15, -v23
    v_fma_f32 v80, v80, s15, -v23
    v_exp_f32 v32, v32
    v_exp_f32 v36, v36
    v_exp_f32 v40, v40
    v_exp_f32 v44, v44
    v_exp_f32 v48, v48
    v_exp_f32 v52, v52
    v_exp_f32 v56, v56
    v_exp_f32 v60, v60
    v_exp_f32 v64, v64
    v_exp_f32 v68, v68
    v_exp_f32 v72, v72
    v_exp_f32 v76, v76
    v_exp_f32 v80, v80
    v_add_f32 v22, v32, v36
    v_add_f32 v22, v22, v40
    v_add_f32 v22, v22, v44
    v_add_f32 v22, v22, v48
    v_add_f32 v22, v22, v52
    v_add_f32 v22, v22, v56
    v_add_f32 v22, v22, v60
    v_add_f32 v22, v22, v64
    v_add_f32 v22, v22, v68
    v_add_f32 v22, v22, v72
    v_add_f32 v22, v22, v76
    v_add_f32 v22, v22, v80
    v_cvt_pk_bf16_f32 v32, v32, v36
    v_cvt_pk_bf16_f32 v40, v40, v44
    v_cvt_pk_bf16_f32 v48, v48, v52
    v_cvt_pk_bf16_f32 v56, v56, v60
    v_cvt_pk_bf16_f32 v64, v64, v68
    v_cvt_pk_bf16_f32 v72, v72, v76
    v_cvt_pk_bf16_f32 v80, v80, v80
    v_mov_b32 v3, v22
    s_nop 1
    v_permlane16_swap_b32 v22, v3
    v_add_f32 v22, v22, v3
    v_mov_b32 v3, v22
    s_nop 1
    v_permlane32_swap_b32 v22, v3
    v_add_f32 v22, v22, v3
    ds_write_b32 v30, v22 offset:9344
    v_mov_b32 v24, 0
    v_mov_b32 v25, 1
    s_mov_b64 exec, 1
    ds_add_rtn_u32 v26, v24, v25 offset:9476
    s_waitcnt lgkmcnt(0)
    v_cmp_eq_u32 vcc, 7, v26
    s_mov_b64 exec, -1
    s_cbranch_vccz L_skip_35
    v_and_b32 v24, 3, v0
    v_lshlrev_b32 v24, 5, v24
    ds_read_b128 v[246:249], v24 offset:9216
    ds_read_b128 v[250:253], v24 offset:9232
    ds_read_b128 v[10:13], v24 offset:9344
    ds_read_b128 v[14:17], v24 offset:9360
    v_mov_b32 v27, s95
    s_lshl_b32 s10, s8, 3
    s_add_u32 s10, s10, s7
    s_mul_i32 s10, s10, 12
    s_add_u32 s10, s10, s9
    s_lshl_b32 s10, s10, 6
    s_add_u32 s10, s10, 294912
    s_mov_b32 s11, 0xffffff00
    s_waitcnt lgkmcnt(0)
    v_max3_f32 v26, v246, v247, v248
    v_max3_f32 v26, v26, v249, v250
    v_max3_f32 v26, v26, v251, v252
    v_max_f32 v26, v26, v253
    v_sub_f32 v246, v246, v26
    v_sub_f32 v247, v247, v26
    v_sub_f32 v248, v248, v26
    v_sub_f32 v249, v249, v26
    v_sub_f32 v250, v250, v26
    v_sub_f32 v251, v251, v26
    v_sub_f32 v252, v252, v26
    v_sub_f32 v253, v253, v26
    v_exp_f32 v246, v246
    v_exp_f32 v247, v247
    v_exp_f32 v248, v248
    v_exp_f32 v249, v249
    v_exp_f32 v250, v250
    v_exp_f32 v251, v251
    v_exp_f32 v252, v252
    v_exp_f32 v253, v253
    v_mul_f32 v25, v246, v10
    v_fmac_f32 v25, v247, v11
    v_fmac_f32 v25, v248, v12
    v_fmac_f32 v25, v249, v13
    v_fmac_f32 v25, v250, v14
    v_fmac_f32 v25, v251, v15
    v_fmac_f32 v25, v252, v16
    v_fmac_f32 v25, v253, v17
    v_bfi_b32 v248, s11, v25, v27
    v_bfi_b32 v246, s11, v26, v27
    v_mov_b32 v247, s94
    v_mov_b32 v249, s94
    s_mov_b64 exec, 15
    buffer_store_dwordx4 v[246:249], v2, s[44:47], s10 offen sc1
    s_mov_b64 exec, -1
L_skip_35:
    v_perm_b32 v230, v32, v32, v4
    v_perm_b32 v231, v32, v32, v5
    v_perm_b32 v234, v32, v32, v6
    v_perm_b32 v235, v32, v32, v7
    v_perm_b32 v238, v40, v40, v4
    v_perm_b32 v239, v40, v40, v5
    v_perm_b32 v242, v40, v40, v6
    v_perm_b32 v243, v40, v40, v7
    s_waitcnt vmcnt(11)
    v_mfma_f32_16x16x32_bf16 v[14:17], v[230:233], v[132:135], 0
    v_mfma_f32_16x16x32_bf16 v[18:21], v[228:231], v[132:135], 0
    s_waitcnt vmcnt(10)
    v_mfma_f32_16x16x32_bf16 v[14:17], v[234:237], v[136:139], v[14:17]
    v_mfma_f32_16x16x32_bf16 v[18:21], v[232:235], v[136:139], v[18:21]
    s_waitcnt vmcnt(9)
    v_mfma_f32_16x16x32_bf16 v[14:17], v[238:241], v[140:143], v[14:17]
    v_mfma_f32_16x16x32_bf16 v[18:21], v[236:239], v[140:143], v[18:21]
    s_waitcnt vmcnt(8)
    v_mfma_f32_16x16x32_bf16 v[14:17], v[242:245], v[144:147], v[14:17]
    v_mfma_f32_16x16x32_bf16 v[18:21], v[240:243], v[144:147], v[18:21]
    v_perm_b32 v230, v48, v48, v4
    v_perm_b32 v231, v48, v48, v5
    v_perm_b32 v234, v48, v48, v6
    v_perm_b32 v235, v48, v48, v7
    v_perm_b32 v238, v56, v56, v4
    v_perm_b32 v239, v56, v56, v5
    v_perm_b32 v242, v56, v56, v6
    v_perm_b32 v243, v56, v56, v7
    s_waitcnt vmcnt(7)
    v_mfma_f32_16x16x32_bf16 v[14:17], v[230:233], v[148:151], v[14:17]
    v_mfma_f32_16x16x32_bf16 v[18:21], v[228:231], v[148:151], v[18:21]
    s_waitcnt vmcnt(6)
    v_mfma_f32_16x16x32_bf16 v[14:17], v[234:237], v[152:155], v[14:17]
    v_mfma_f32_16x16x32_bf16 v[18:21], v[232:235], v[152:155], v[18:21]
    s_waitcnt vmcnt(5)
    v_mfma_f32_16x16x32_bf16 v[14:17], v[238:241], v[156:159], v[14:17]
    v_mfma_f32_16x16x32_bf16 v[18:21], v[236:239], v[156:159], v[18:21]
    s_waitcnt vmcnt(4)
    v_mfma_f32_16x16x32_bf16 v[14:17], v[242:245], v[160:163], v[14:17]
    v_mfma_f32_16x16x32_bf16 v[18:21], v[240:243], v[160:163], v[18:21]
    v_perm_b32 v230, v64, v64, v4
    v_perm_b32 v231, v64, v64, v5
    v_perm_b32 v234, v64, v64, v6
    v_perm_b32 v235, v64, v64, v7
    v_perm_b32 v238, v72, v72, v4
    v_perm_b32 v239, v72, v72, v5
    v_perm_b32 v242, v72, v72, v6
    v_perm_b32 v243, v72, v72, v7
    s_waitcnt vmcnt(3)
    buffer_load_dwordx4 v[180:183], v2, s[52:55], s6 offen offset:0 nt
    v_mfma_f32_16x16x32_bf16 v[14:17], v[230:233], v[164:167], v[14:17]
    v_mfma_f32_16x16x32_bf16 v[18:21], v[228:231], v[164:167], v[18:21]
    s_waitcnt vmcnt(3)
    v_mfma_f32_16x16x32_bf16 v[14:17], v[234:237], v[168:171], v[14:17]
    v_mfma_f32_16x16x32_bf16 v[18:21], v[232:235], v[168:171], v[18:21]
    s_waitcnt vmcnt(2)
    v_mfma_f32_16x16x32_bf16 v[14:17], v[238:241], v[172:175], v[14:17]
    v_mfma_f32_16x16x32_bf16 v[18:21], v[236:239], v[172:175], v[18:21]
    s_waitcnt vmcnt(1)
    v_mfma_f32_16x16x32_bf16 v[14:17], v[242:245], v[176:179], v[14:17]
    v_mfma_f32_16x16x32_bf16 v[18:21], v[240:243], v[176:179], v[18:21]
    v_perm_b32 v230, v80, v80, v4
    v_perm_b32 v231, v80, v80, v5
    v_mov_b32 v24, 0
    v_lshrrev_b32 v25, 4, v0
    v_lshlrev_b32 v25, 5, v25
    s_lshl_b32 s10, s3, 2
    v_add_u32 v26, s10, v25
L_spin_36:
    ds_read_b32 v27, v24 offset:9476
    ds_read_b128 v[246:249], v25 offset:9216
    ds_read_b128 v[250:253], v25 offset:9232
    ds_read_b32 v22, v26 offset:9216
    s_waitcnt lgkmcnt(0)
    v_cmp_ne_u32 vcc, 8, v27
    s_cbranch_vccz L_ok_37
    s_sleep 1
    s_sub_u32 s14, s14, 1
    s_cbranch_scc0 L_spin_36
L_ok_37:
    v_max3_f32 v23, v246, v247, v248
    v_max3_f32 v23, v23, v249, v250
    v_max3_f32 v23, v23, v251, v252
    v_max_f32 v23, v23, v253
    v_sub_f32 v22, v22, v23
    v_exp_f32 v22, v22
    s_lshl_b32 s10, s3, 11
    v_lshl_add_u32 v24, v0, 5, s10
    s_lshl_b32 s10, s3, 8
    v_and_b32 v26, 31, v0
    v_lshl_add_u32 v25, v26, 3, s10
    v_lshlrev_b32 v26, 2, v0
    s_lshl_b32 s10, s7, 2
    s_lshr_b32 s11, s3, 1
    s_add_u32 s10, s10, s11
    s_lshl_b32 s10, s10, 15
    s_mul_i32 s11, s8, 24
    s_add_u32 s11, s11, s9
    s_add_u32 s11, s11, s9
    s_and_b32 s12, s3, 1
    s_add_u32 s11, s11, s12
    s_lshl_b32 s11, s11, 7
    s_add_u32 s10, s10, s11
    s_add_u32 s10, s10, 1048576
    s_waitcnt vmcnt(0)
    v_mfma_f32_16x16x32_bf16 v[14:17], v[230:233], v[180:183], v[14:17]
    v_mfma_f32_16x16x32_bf16 v[18:21], v[228:231], v[180:183], v[18:21]
    s_nop 6
    v_mul_f32 v14, v14, v22
    v_mul_f32 v15, v15, v22
    v_mul_f32 v16, v16, v22
    v_mul_f32 v17, v17, v22
    v_mul_f32 v18, v18, v22
    v_mul_f32 v19, v19, v22
    v_mul_f32 v20, v20, v22
    v_mul_f32 v21, v21, v22
    ds_write_b128 v24, v[14:17] offset:16384
    ds_write_b128 v24, v[18:21] offset:16400
    s_waitcnt lgkmcnt(0)
    s_barrier
    ds_read_b64 v[36:37], v25 offset:16384
    ds_read_b64 v[38:39], v25 offset:18432
    ds_read_b64 v[40:41], v25 offset:20480
    ds_read_b64 v[42:43], v25 offset:22528
    ds_read_b64 v[44:45], v25 offset:24576
    ds_read_b64 v[46:47], v25 offset:26624
    ds_read_b64 v[48:49], v25 offset:28672
    ds_read_b64 v[50:51], v25 offset:30720
    s_waitcnt lgkmcnt(6)
    v_add_f32 v36, v36, v38
    v_add_f32 v37, v37, v39
    s_waitcnt lgkmcnt(4)
    v_add_f32 v40, v40, v42
    v_add_f32 v41, v41, v43
    v_add_f32 v36, v36, v40
    v_add_f32 v37, v37, v41
    s_waitcnt lgkmcnt(2)
    v_add_f32 v44, v44, v46
    v_add_f32 v45, v45, v47
    v_add_f32 v36, v36, v44
    v_add_f32 v37, v37, v45
    s_waitcnt lgkmcnt(0)
    v_add_f32 v48, v48, v50
    v_add_f32 v49, v49, v51
    v_add_f32 v36, v36, v48
    v_add_f32 v37, v37, v49
    v_cvt_pk_bf16_f32 v36, v36, v37
    v_min_u32 v36, -2, v36
    s_mov_b32 exec_hi, 0
    buffer_store_dword v36, v26, s[44:47], s10 offen sc1
    s_mov_b64 exec, -1
    s_mov_b32 s4, s68
    s_cmp_lt_u32 s3, 4
    s_cbranch_scc1 L_ATAIL
    s_endpgm
L_ATAIL:
    s_mov_b32 s5, s3
    s_mov_b32 s6, 0
    s_mov_b32 s14, 20000
    s_cmp_eq_u32 s3, 0
    s_cselect_b32 s69, 0, 0x40000000
    s_and_b32 s70, s4, 7
    s_lshl_b32 s70, s70, 11
    s_add_u32 s70, s70, 525824
    s_add_u32 s70, s70, s69
    v_lshlrev_b32 v18, 3, v0
    buffer_load_dwordx2 v[16:17], v18, s[44:47], s70 offen sc1
    v_lshrrev_b32 v2, 4, v0
    v_lshlrev_b32 v2, 14, v2
    v_and_b32 v11, 15, v0
    v_lshl_add_u32 v2, v11, 4, v2
    v_lshlrev_b32 v1, 4, v0
    s_lshl_b32 s7, s3, 11
    s_lshl_b32 s8, s4, 14
    s_add_u32 s8, s8, 1048576
    v_lshl_add_u32 v13, v0, 2, s7
    v_bfe_u32 v14, v0, 3, 1
    v_lshlrev_b32 v14, 7, v14
    v_lshrrev_b32 v11, 4, v0
    v_lshl_add_u32 v14, v11, 5, v14
    v_add_u32 v14, s7, v14
    v_lshrrev_b32 v15, 5, v0
    v_lshlrev_b32 v15, 17, v15
    v_bfe_u32 v11, v0, 3, 1
    v_lshl_add_u32 v15, v11, 14, v15
    v_and_b32 v11, 7, v0
    v_lshl_add_u32 v15, v11, 4, v15
    v_and_b32 v3, 1, v0
    v_cmp_eq_u32 vcc, 1, v3
    v_mov_b32 v8, 0x0c0c0100
    v_mov_b32 v3, 0x01000c0c
    v_cndmask_b32 v8, v8, v3, vcc
    v_add_u32 v9, 0x0202, v8
    v_mov_b32 v3, 0x03020c0c
    v_cndmask_b32 v9, v9, v3, vcc
    v_and_b32 v3, 2, v0
    v_cmp_eq_u32 vcc, 0, v3
    v_mov_b32 v3, 0x0c0c0c0c
    s_nop 0
    v_cndmask_b32 v4, v3, v8, vcc
    v_cndmask_b32 v5, v8, v3, vcc
    v_cndmask_b32 v6, v3, v9, vcc
    v_cndmask_b32 v7, v9, v3, vcc
    s_lshl_b32 s10, s3, 14
    s_add_u32 s10, s10, 32768
    v_add_u32 v10, s10, v1
    v_add_u32 v11, 65536, v10
    ds_read_b128 v[96:99], v10 offset:0
    ds_read_b128 v[100:103], v10 offset:1024
    ds_read_b128 v[104:107], v10 offset:2048
    ds_read_b128 v[108:111], v10 offset:3072
    ds_read_b128 v[112:115], v10 offset:4096
    ds_read_b128 v[116:119], v10 offset:5120
    ds_read_b128 v[120:123], v10 offset:6144
    ds_read_b128 v[124:127], v10 offset:7168
    ds_read_b128 v[128:131], v10 offset:8192
    ds_read_b128 v[132:135], v10 offset:9216
    ds_read_b128 v[136:139], v10 offset:10240
    ds_read_b128 v[140:143], v10 offset:11264
    ds_read_b128 v[144:147], v10 offset:12288
    ds_read_b128 v[148:151], v10 offset:13312
    ds_read_b128 v[152:155], v10 offset:14336
    s_waitcnt lgkmcnt(12)
    ds_read_b128 v[156:159], v10 offset:15360
    ds_read_b128 v[32:35], v11 offset:0
    ds_read_b128 v[36:39], v11 offset:1024
    s_waitcnt lgkmcnt(12)
    ds_read_b128 v[40:43], v11 offset:2048
    ds_read_b128 v[44:47], v11 offset:3072
    ds_read_b128 v[48:51], v11 offset:4096
    s_waitcnt lgkmcnt(12)
    ds_read_b128 v[52:55], v11 offset:5120
    ds_read_b128 v[56:59], v11 offset:6144
    ds_read_b128 v[60:63], v11 offset:7168
    s_waitcnt lgkmcnt(12)
    ds_read_b128 v[64:67], v11 offset:8192
    ds_read_b128 v[68:71], v11 offset:9216
    ds_read_b128 v[72:75], v11 offset:10240
    s_waitcnt lgkmcnt(12)
    ds_read_b128 v[76:79], v11 offset:11264
    ds_read_b128 v[80:83], v11 offset:12288
    ds_read_b128 v[84:87], v11 offset:13312
    s_waitcnt lgkmcnt(12)
    ds_read_b128 v[88:91], v11 offset:14336
    ds_read_b128 v[92:95], v11 offset:15360
    s_cmp_lg_u32 s3, 0
    s_cbranch_scc1 L_ok_39
L_spin_38:
    s_waitcnt vmcnt(0)
    v_cmp_ne_u64 vcc, s[94:95], v[16:17]
    s_cbranch_vccz L_ok_39
    buffer_load_dwordx2 v[16:17], v18, s[44:47], s70 offen sc1
    s_sub_u32 s14, s14, 1
    s_cbranch_scc0 L_spin_38
L_ok_39:
    s_waitcnt vmcnt(0) lgkmcnt(0)
    s_barrier
    s_lshr_b32 s12, s4, 1
    s_lshl_b32 s10, s12, 3
    s_add_u32 s10, s10, 262144
    v_lshlrev_b32 v10, 8, v0
    buffer_load_dwordx2 v[16:17], v10, s[44:47], s10 offen sc1
    s_lshl_b32 s10, s12, 16
    s_lshl_b32 s11, s5, 8
    s_add_u32 s10, s10, s11
    s_add_u32 s10, s10, 2097152
    buffer_load_dwordx4 v[160:163], v2, s[44:47], s10 offen offset:0 sc1
    buffer_load_dwordx4 v[164:167], v2, s[44:47], s10 offen offset:1024 sc1
    buffer_load_dwordx4 v[168:171], v2, s[44:47], s10 offen offset:2048 sc1
    buffer_load_dwordx4 v[172:175], v2, s[44:47], s10 offen offset:3072 sc1
    s_add_u32 s10, s10, 4096
    buffer_load_dwordx4 v[176:179], v2, s[44:47], s10 offen offset:0 sc1
    buffer_load_dwordx4 v[180:183], v2, s[44:47], s10 offen offset:1024 sc1
    buffer_load_dwordx4 v[184:187], v2, s[44:47], s10 offen offset:2048 sc1
    buffer_load_dwordx4 v[188:191], v2, s[44:47], s10 offen offset:3072 sc1
    s_add_u32 s10, s10, 4096
    buffer_load_dwordx4 v[192:195], v2, s[44:47], s10 offen offset:0 sc1
    buffer_load_dwordx4 v[196:199], v2, s[44:47], s10 offen offset:1024 sc1
    buffer_load_dwordx4 v[200:203], v2, s[44:47], s10 offen offset:2048 sc1
    buffer_load_dwordx4 v[204:207], v2, s[44:47], s10 offen offset:3072 sc1
    s_add_u32 s10, s10, 4096
    buffer_load_dwordx4 v[208:211], v2, s[44:47], s10 offen offset:0 sc1
    buffer_load_dwordx4 v[212:215], v2, s[44:47], s10 offen offset:1024 sc1
    buffer_load_dwordx4 v[216:219], v2, s[44:47], s10 offen offset:2048 sc1
    buffer_load_dwordx4 v[220:223], v2, s[44:47], s10 offen offset:3072 sc1
    s_add_u32 s10, s10, 4096
    s_mov_b32 s72, 0x30003
    s_mov_b32 s73, 0x3000300
    s_mov_b32 s74, 0xc000c
    s_mov_b32 s75, 0xc000c00
    s_mov_b32 s76, 0x300030
    s_mov_b32 s77, 0x30003000
    s_mov_b32 s78, 0xc000c0
    s_mov_b32 s79, 0xc000c000
    v_lshl_add_u32 v10, v0, 1, s7
    v_lshrrev_b32 v11, 4, v0
    v_lshl_add_u32 v11, v11, 5, s7
    s_waitcnt vmcnt(16)
    v_mov_b32 v18, v16
    s_nop 1
    v_max_f32_dpp v18, v18, v18 row_ror:1 row_mask:0xf bank_mask:0xf
    s_nop 1
    v_max_f32_dpp v18, v18, v18 row_ror:2 row_mask:0xf bank_mask:0xf
    s_nop 1
    v_max_f32_dpp v18, v18, v18 row_ror:4 row_mask:0xf bank_mask:0xf
    s_nop 1
    v_max_f32_dpp v18, v18, v18 row_ror:8 row_mask:0xf bank_mask:0xf
    v_mov_b32 v3, v18
    s_nop 1
    v_permlane16_swap_b32 v18, v3
    v_max_f32 v18, v18, v3
    v_sub_f32 v16, v16, v18
    v_exp_f32 v16, v16
    s_nop 0
    v_mul_f32 v17, v16, v17
    s_nop 1
    v_add_f32_dpp v17, v17, v17 row_ror:1 row_mask:0xf bank_mask:0xf
    s_nop 1
    v_add_f32_dpp v17, v17, v17 row_ror:2 row_mask:0xf bank_mask:0xf
    s_nop 1
    v_add_f32_dpp v17, v17, v17 row_ror:4 row_mask:0xf bank_mask:0xf
    s_nop 1
    v_add_f32_dpp v17, v17, v17 row_ror:8 row_mask:0xf bank_mask:0xf
    v_mov_b32 v3, v17
    s_nop 1
    v_permlane16_swap_b32 v17, v3
    v_add_f32 v17, v17, v3
    v_rcp_f32 v17, v17
    s_nop 0
    v_mul_f32 v16, v16, v17
    v_cvt_pk_bf16_f32 v16, v16, v16
    ds_write_b16 v10, v16
    ds_read_b128 v[244:247], v11
    ds_read_b128 v[248:251], v11 offset:16
    v_lshrrev_b32 v10, 5, v0
    v_lshlrev_b32 v10, 8, v10
    v_and_b32 v11, 15, v0
    v_lshl_add_u32 v10, v11, 1, v10
    v_bfe_u32 v11, v0, 4, 1
    v_lshl_add_u32 v10, v11, 5, v10
    v_add_u32 v10, s7, v10
    v_bfe_u32 v11, v0, 3, 1
    v_lshlrev_b32 v11, 8, v11
    v_lshrrev_b32 v12, 4, v0
    v_lshl_add_u32 v11, v12, 6, v11
    v_bfe_u32 v12, v0, 2, 1
    v_lshl_add_u32 v11, v12, 5, v11
    v_add_u32 v11, s7, v11
    s_waitcnt lgkmcnt(0)
    v_perm_b32 v232, v244, v244, v8
    v_cndmask_b32 v234, 0, v232, s[72:73]
    v_cndmask_b32 v235, 0, v232, s[74:75]
    v_cndmask_b32 v236, 0, v232, s[76:77]
    v_cndmask_b32 v237, 0, v232, s[78:79]
    s_waitcnt vmcnt(15)
    s_nop 0
    v_mfma_f32_16x16x32_bf16 v[224:227], v[234:237], v[160:163], 0
    v_perm_b32 v232, v244, v244, v9
    v_cndmask_b32 v238, 0, v232, s[72:73]
    v_cndmask_b32 v239, 0, v232, s[74:75]
    v_cndmask_b32 v240, 0, v232, s[76:77]
    v_cndmask_b32 v241, 0, v232, s[78:79]
    s_waitcnt vmcnt(14)
    s_nop 0
    v_mfma_f32_16x16x32_bf16 v[224:227], v[238:241], v[164:167], v[224:227]
    v_perm_b32 v232, v245, v245, v8
    v_cndmask_b32 v234, 0, v232, s[72:73]
    v_cndmask_b32 v235, 0, v232, s[74:75]
    v_cndmask_b32 v236, 0, v232, s[76:77]
    v_cndmask_b32 v237, 0, v232, s[78:79]
    s_waitcnt vmcnt(13)
    s_nop 0
    v_mfma_f32_16x16x32_bf16 v[224:227], v[234:237], v[168:171], v[224:227]
    v_perm_b32 v232, v245, v245, v9
    v_cndmask_b32 v238, 0, v232, s[72:73]
    v_cndmask_b32 v239, 0, v232, s[74:75]
    v_cndmask_b32 v240, 0, v232, s[76:77]
    v_cndmask_b32 v241, 0, v232, s[78:79]
    s_waitcnt vmcnt(12)
    s_nop 0
    v_mfma_f32_16x16x32_bf16 v[224:227], v[238:241], v[172:175], v[224:227]
    v_perm_b32 v232, v246, v246, v8
    v_cndmask_b32 v234, 0, v232, s[72:73]
    v_cndmask_b32 v235, 0, v232, s[74:75]
    v_cndmask_b32 v236, 0, v232, s[76:77]
    v_cndmask_b32 v237, 0, v232, s[78:79]
    s_waitcnt vmcnt(11)
    s_nop 0
    v_mfma_f32_16x16x32_bf16 v[224:227], v[234:237], v[176:179], v[224:227]
    v_perm_b32 v232, v246, v246, v9
    v_cndmask_b32 v238, 0, v232, s[72:73]
    v_cndmask_b32 v239, 0, v232, s[74:75]
    v_cndmask_b32 v240, 0, v232, s[76:77]
    v_cndmask_b32 v241, 0, v232, s[78:79]
    s_waitcnt vmcnt(10)
    s_nop 0
    v_mfma_f32_16x16x32_bf16 v[224:227], v[238:241], v[180:183], v[224:227]
    v_perm_b32 v232, v247, v247, v8
    v_cndmask_b32 v234, 0, v232, s[72:73]
    v_cndmask_b32 v235, 0, v232, s[74:75]
    v_cndmask_b32 v236, 0, v232, s[76:77]
    v_cndmask_b32 v237, 0, v232, s[78:79]
    s_waitcnt vmcnt(9)
    s_nop 0
    v_mfma_f32_16x16x32_bf16 v[224:227], v[234:237], v[184:187], v[224:227]
    v_perm_b32 v232, v247, v247, v9
    v_cndmask_b32 v238, 0, v232, s[72:73]
    v_cndmask_b32 v239, 0, v232, s[74:75]
    v_cndmask_b32 v240, 0, v232, s[76:77]
    v_cndmask_b32 v241, 0, v232, s[78:79]
    s_waitcnt vmcnt(8)
    s_nop 0
    v_mfma_f32_16x16x32_bf16 v[224:227], v[238:241], v[188:191], v[224:227]
    v_perm_b32 v232, v248, v248, v8
    v_cndmask_b32 v234, 0, v232, s[72:73]
    v_cndmask_b32 v235, 0, v232, s[74:75]
    v_cndmask_b32 v236, 0, v232, s[76:77]
    v_cndmask_b32 v237, 0, v232, s[78:79]
    s_waitcnt vmcnt(7)
    s_nop 0
    v_mfma_f32_16x16x32_bf16 v[224:227], v[234:237], v[192:195], v[224:227]
    v_perm_b32 v232, v248, v248, v9
    v_cndmask_b32 v238, 0, v232, s[72:73]
    v_cndmask_b32 v239, 0, v232, s[74:75]
    v_cndmask_b32 v240, 0, v232, s[76:77]
    v_cndmask_b32 v241, 0, v232, s[78:79]
    s_waitcnt vmcnt(6)
    s_nop 0
    v_mfma_f32_16x16x32_bf16 v[224:227], v[238:241], v[196:199], v[224:227]
    v_perm_b32 v232, v249, v249, v8
    v_cndmask_b32 v234, 0, v232, s[72:73]
    v_cndmask_b32 v235, 0, v232, s[74:75]
    v_cndmask_b32 v236, 0, v232, s[76:77]
    v_cndmask_b32 v237, 0, v232, s[78:79]
    s_waitcnt vmcnt(5)
    s_nop 0
    v_mfma_f32_16x16x32_bf16 v[224:227], v[234:237], v[200:203], v[224:227]
    v_perm_b32 v232, v249, v249, v9
    v_cndmask_b32 v238, 0, v232, s[72:73]
    v_cndmask_b32 v239, 0, v232, s[74:75]
    v_cndmask_b32 v240, 0, v232, s[76:77]
    v_cndmask_b32 v241, 0, v232, s[78:79]
    s_waitcnt vmcnt(4)
    s_nop 0
    v_mfma_f32_16x16x32_bf16 v[224:227], v[238:241], v[204:207], v[224:227]
    v_perm_b32 v232, v250, v250, v8
    v_cndmask_b32 v234, 0, v232, s[72:73]
    v_cndmask_b32 v235, 0, v232, s[74:75]
    v_cndmask_b32 v236, 0, v232, s[76:77]
    v_cndmask_b32 v237, 0, v232, s[78:79]
    s_waitcnt vmcnt(3)
    s_nop 0
    v_mfma_f32_16x16x32_bf16 v[224:227], v[234:237], v[208:211], v[224:227]
    v_perm_b32 v232, v250, v250, v9
    v_cndmask_b32 v238, 0, v232, s[72:73]
    v_cndmask_b32 v239, 0, v232, s[74:75]
    v_cndmask_b32 v240, 0, v232, s[76:77]
    v_cndmask_b32 v241, 0, v232, s[78:79]
    s_waitcnt vmcnt(2)
    s_nop 0
    v_mfma_f32_16x16x32_bf16 v[224:227], v[238:241], v[212:215], v[224:227]
    v_perm_b32 v232, v251, v251, v8
    v_cndmask_b32 v234, 0, v232, s[72:73]
    v_cndmask_b32 v235, 0, v232, s[74:75]
    v_cndmask_b32 v236, 0, v232, s[76:77]
    v_cndmask_b32 v237, 0, v232, s[78:79]
    s_waitcnt vmcnt(1)
    s_nop 0
    v_mfma_f32_16x16x32_bf16 v[224:227], v[234:237], v[216:219], v[224:227]
    v_perm_b32 v232, v251, v251, v9
    v_cndmask_b32 v238, 0, v232, s[72:73]
    v_cndmask_b32 v239, 0, v232, s[74:75]
    v_cndmask_b32 v240, 0, v232, s[76:77]
    v_cndmask_b32 v241, 0, v232, s[78:79]
    s_waitcnt vmcnt(0)
    s_nop 0
    v_mfma_f32_16x16x32_bf16 v[224:227], v[238:241], v[220:223], v[224:227]
    s_nop 7
    v_cvt_pk_bf16_f32 v16, v224, v225
    v_cvt_pk_bf16_f32 v17, v226, v227
    ds_write_b16 v10, v16 offset:256
    ds_write_b16_d16_hi v10, v16 offset:320
    ds_write_b16 v10, v17 offset:384
    ds_write_b16_d16_hi v10, v17 offset:448
    ds_read_b128 v[244:247], v11 offset:256
    ds_read_b128 v[248:251], v11 offset:272
    s_mov_b32 s72, 0x3030303
    s_mov_b32 s73, 0x3030303
    s_mov_b32 s74, 0xc0c0c0c
    s_mov_b32 s75, 0xc0c0c0c
    s_mov_b32 s76, 0x30303030
    s_mov_b32 s77, 0x30303030
    s_mov_b32 s78, 0xc0c0c0c0
    s_mov_b32 s79, 0xc0c0c0c0
    v_mov_b32 v3, 0x0c0c0c0c
    v_cndmask_b32 v208, v3, v8, s[72:73]
    v_cndmask_b32 v209, v3, v8, s[74:75]
    v_cndmask_b32 v210, v3, v8, s[76:77]
    v_cndmask_b32 v211, v3, v8, s[78:79]
    v_cndmask_b32 v212, v3, v9, s[72:73]
    v_cndmask_b32 v213, v3, v9, s[74:75]
    v_cndmask_b32 v214, v3, v9, s[76:77]
    v_cndmask_b32 v215, v3, v9, s[78:79]
    v_mov_b32 v232, 0
    v_mov_b32 v233, 0
    v_mov_b32 v236, 0
    v_mov_b32 v237, 0
    v_mov_b32 v240, 0
    v_mov_b32 v241, 0
    v_bfe_u32 v10, v0, 3, 1
    v_lshlrev_b32 v10, 9, v10
    v_lshrrev_b32 v11, 5, v0
    v_lshl_add_u32 v10, v11, 8, v10
    v_and_b32 v11, 7, v0
    v_lshl_add_u32 v10, v11, 5, v10
    s_lshl_b32 s10, s5, 10
    v_add_u32 v10, s10, v10
    s_waitcnt lgkmcnt(0)
    v_perm_b32 v234, v244, v244, v4
    v_perm_b32 v235, v244, v244, v5
    s_nop 1
    v_mfma_f32_16x16x32_bf16 v[224:227], v[234:237], v[96:99], 0
    v_mfma_f32_16x16x32_bf16 v[228:231], v[232:235], v[96:99], 0
    v_perm_b32 v238, v244, v244, v6
    v_perm_b32 v239, v244, v244, v7
    s_nop 1
    v_mfma_f32_16x16x32_bf16 v[224:227], v[238:241], v[100:103], v[224:227]
    v_mfma_f32_16x16x32_bf16 v[228:231], v[236:239], v[100:103], v[228:231]
    v_perm_b32 v234, v245, v245, v4
    v_perm_b32 v235, v245, v245, v5
    s_nop 1
    v_mfma_f32_16x16x32_bf16 v[224:227], v[234:237], v[104:107], v[224:227]
    v_mfma_f32_16x16x32_bf16 v[228:231], v[232:235], v[104:107], v[228:231]
    v_perm_b32 v238, v245, v245, v6
    v_perm_b32 v239, v245, v245, v7
    s_nop 1
    v_mfma_f32_16x16x32_bf16 v[224:227], v[238:241], v[108:111], v[224:227]
    v_mfma_f32_16x16x32_bf16 v[228:231], v[236:239], v[108:111], v[228:231]
    v_perm_b32 v234, v246, v246, v4
    v_perm_b32 v235, v246, v246, v5
    s_nop 1
    v_mfma_f32_16x16x32_bf16 v[224:227], v[234:237], v[112:115], v[224:227]
    v_mfma_f32_16x16x32_bf16 v[228:231], v[232:235], v[112:115], v[228:231]
    v_perm_b32 v238, v246, v246, v6
    v_perm_b32 v239, v246, v246, v7
    s_nop 1
    v_mfma_f32_16x16x32_bf16 v[224:227], v[238:241], v[116:119], v[224:227]
    v_mfma_f32_16x16x32_bf16 v[228:231], v[236:239], v[116:119], v[228:231]
    v_perm_b32 v234, v247, v247, v4
    v_perm_b32 v235, v247, v247, v5
    s_nop 1
    v_mfma_f32_16x16x32_bf16 v[224:227], v[234:237], v[120:123], v[224:227]
    v_mfma_f32_16x16x32_bf16 v[228:231], v[232:235], v[120:123], v[228:231]
    v_perm_b32 v238, v247, v247, v6
    v_perm_b32 v239, v247, v247, v7
    s_nop 1
    v_mfma_f32_16x16x32_bf16 v[224:227], v[238:241], v[124:127], v[224:227]
    v_mfma_f32_16x16x32_bf16 v[228:231], v[236:239], v[124:127], v[228:231]
    v_perm_b32 v234, v248, v248, v4
    v_perm_b32 v235, v248, v248, v5
    s_nop 1
    v_mfma_f32_16x16x32_bf16 v[224:227], v[234:237], v[128:131], v[224:227]
    v_mfma_f32_16x16x32_bf16 v[228:231], v[232:235], v[128:131], v[228:231]
    v_perm_b32 v238, v248, v248, v6
    v_perm_b32 v239, v248, v248, v7
    s_nop 1
    v_mfma_f32_16x16x32_bf16 v[224:227], v[238:241], v[132:135], v[224:227]
    v_mfma_f32_16x16x32_bf16 v[228:231], v[236:239], v[132:135], v[228:231]
    v_perm_b32 v234, v249, v249, v4
    v_perm_b32 v235, v249, v249, v5
    s_nop 1
    v_mfma_f32_16x16x32_bf16 v[224:227], v[234:237], v[136:139], v[224:227]
    v_mfma_f32_16x16x32_bf16 v[228:231], v[232:235], v[136:139], v[228:231]
    v_perm_b32 v238, v249, v249, v6
    v_perm_b32 v239, v249, v249, v7
    s_nop 1
    v_mfma_f32_16x16x32_bf16 v[224:227], v[238:241], v[140:143], v[224:227]
    v_mfma_f32_16x16x32_bf16 v[228:231], v[236:239], v[140:143], v[228:231]
    v_perm_b32 v234, v250, v250, v4
    v_perm_b32 v235, v250, v250, v5
    s_nop 1
    v_mfma_f32_16x16x32_bf16 v[224:227], v[234:237], v[144:147], v[224:227]
    v_mfma_f32_16x16x32_bf16 v[228:231], v[232:235], v[144:147], v[228:231]
    v_perm_b32 v238, v250, v250, v6
    v_perm_b32 v239, v250, v250, v7
    s_nop 1
    v_mfma_f32_16x16x32_bf16 v[224:227], v[238:241], v[148:151], v[224:227]
    v_mfma_f32_16x16x32_bf16 v[228:231], v[236:239], v[148:151], v[228:231]
    v_perm_b32 v234, v251, v251, v4
    v_perm_b32 v235, v251, v251, v5
    s_nop 1
    v_mfma_f32_16x16x32_bf16 v[224:227], v[234:237], v[152:155], v[224:227]
    v_mfma_f32_16x16x32_bf16 v[228:231], v[232:235], v[152:155], v[228:231]
    v_perm_b32 v238, v251, v251, v6
    v_perm_b32 v239, v251, v251, v7
    s_nop 1
    v_mfma_f32_16x16x32_bf16 v[224:227], v[238:241], v[156:159], v[224:227]
    v_mfma_f32_16x16x32_bf16 v[228:231], v[236:239], v[156:159], v[228:231]
    s_mov_b32 exec_lo, 0xff0000ff
    s_mov_b32 exec_hi, 0xff0000ff
    s_nop 4
    ds_write_b128 v10, v[224:227] offset:16384
    ds_write_b128 v10, v[228:231] offset:16400
    s_mov_b64 exec, -1
    v_lshlrev_b32 v10, 3, v0
    s_waitcnt lgkmcnt(0)
    s_barrier
    ds_read_b64 v[16:17], v10 offset:16384
    ds_read_b64 v[18:19], v10 offset:16896
    ds_read_b64 v[20:21], v10 offset:17408
    ds_read_b64 v[22:23], v10 offset:17920
    ds_read_b64 v[24:25], v10 offset:18432
    ds_read_b64 v[26:27], v10 offset:18944
    ds_read_b64 v[28:29], v10 offset:19456
    ds_read_b64 v[30:31], v10 offset:19968
    s_waitcnt lgkmcnt(0)
    v_add_f32 v16, v16, v18
    v_add_f32 v17, v17, v19
    v_add_f32 v20, v20, v22
    v_add_f32 v21, v21, v23
    v_add_f32 v24, v24, v26
    v_add_f32 v25, v25, v27
    v_add_f32 v28, v28, v30
    v_add_f32 v29, v29, v31
    v_add_f32 v16, v16, v20
    v_add_f32 v17, v17, v21
    v_add_f32 v24, v24, v28
    v_add_f32 v25, v25, v29
    v_add_f32 v16, v16, v24
    v_add_f32 v17, v17, v25
    v_cvt_pk_bf16_f32 v16, v16, v17
    ds_write_b32 v13, v16 offset:1024
L_CORE1:
    ds_read_b128 v[244:247], v14 offset:1024
    ds_read_b128 v[248:251], v14 offset:1040
L_CORE2:
    s_lshl_b32 s10, s5, 15
    s_lshl_b32 s11, s4, 7
    s_add_u32 s10, s10, s11
    s_lshl_b32 s11, s6, 18
    s_add_u32 s10, s10, s11
    s_add_u32 s10, s10, 1056768
    s_waitcnt lgkmcnt(0)
    v_perm_b32 v234, v244, v244, v208
    v_perm_b32 v235, v244, v244, v209
    v_perm_b32 v236, v244, v244, v210
    v_perm_b32 v237, v244, v244, v211
    s_nop 1
    v_mfma_f32_16x16x32_bf16 v[224:227], v[234:237], v[32:35], 0
    v_perm_b32 v238, v244, v244, v212
    v_perm_b32 v239, v244, v244, v213
    v_perm_b32 v240, v244, v244, v214
    v_perm_b32 v241, v244, v244, v215
    s_nop 1
    v_mfma_f32_16x16x32_bf16 v[224:227], v[238:241], v[36:39], v[224:227]
    v_perm_b32 v234, v245, v245, v208
    v_perm_b32 v235, v245, v245, v209
    v_perm_b32 v236, v245, v245, v210
    v_perm_b32 v237, v245, v245, v211
    s_nop 1
    v_mfma_f32_16x16x32_bf16 v[224:227], v[234:237], v[40:43], v[224:227]
    v_perm_b32 v238, v245, v245, v212
    v_perm_b32 v239, v245, v245, v213
    v_perm_b32 v240, v245, v245, v214
    v_perm_b32 v241, v245, v245, v215
    s_nop 1
    v_mfma_f32_16x16x32_bf16 v[224:227], v[238:241], v[44:47], v[224:227]
    v_perm_b32 v234, v246, v246, v208
    v_perm_b32 v235, v246, v246, v209
    v_perm_b32 v236, v246, v246, v210
    v_perm_b32 v237, v246, v246, v211
    s_nop 1
    v_mfma_f32_16x16x32_bf16 v[224:227], v[234:237], v[48:51], v[224:227]
    v_perm_b32 v238, v246, v246, v212
    v_perm_b32 v239, v246, v246, v213
    v_perm_b32 v240, v246, v246, v214
    v_perm_b32 v241, v246, v246, v215
    s_nop 1
    v_mfma_f32_16x16x32_bf16 v[224:227], v[238:241], v[52:55], v[224:227]
    v_perm_b32 v234, v247, v247, v208
    v_perm_b32 v235, v247, v247, v209
    v_perm_b32 v236, v247, v247, v210
    v_perm_b32 v237, v247, v247, v211
    s_nop 1
    v_mfma_f32_16x16x32_bf16 v[224:227], v[234:237], v[56:59], v[224:227]
    v_perm_b32 v238, v247, v247, v212
    v_perm_b32 v239, v247, v247, v213
    v_perm_b32 v240, v247, v247, v214
    v_perm_b32 v241, v247, v247, v215
    s_nop 1
    v_mfma_f32_16x16x32_bf16 v[224:227], v[238:241], v[60:63], v[224:227]
    v_perm_b32 v234, v248, v248, v208
    v_perm_b32 v235, v248, v248, v209
    v_perm_b32 v236, v248, v248, v210
    v_perm_b32 v237, v248, v248, v211
    s_nop 1
    v_mfma_f32_16x16x32_bf16 v[224:227], v[234:237], v[64:67], v[224:227]
    v_perm_b32 v238, v248, v248, v212
    v_perm_b32 v239, v248, v248, v213
    v_perm_b32 v240, v248, v248, v214
    v_perm_b32 v241, v248, v248, v215
    s_nop 1
    v_mfma_f32_16x16x32_bf16 v[224:227], v[238:241], v[68:71], v[224:227]
    v_perm_b32 v234, v249, v249, v208
    v_perm_b32 v235, v249, v249, v209
    v_perm_b32 v236, v249, v249, v210
    v_perm_b32 v237, v249, v249, v211
    s_nop 1
    v_mfma_f32_16x16x32_bf16 v[224:227], v[234:237], v[72:75], v[224:227]
    v_perm_b32 v238, v249, v249, v212
    v_perm_b32 v239, v249, v249, v213
    v_perm_b32 v240, v249, v249, v214
    v_perm_b32 v241, v249, v249, v215
    s_nop 1
    v_mfma_f32_16x16x32_bf16 v[224:227], v[238:241], v[76:79], v[224:227]
    v_perm_b32 v234, v250, v250, v208
    v_perm_b32 v235, v250, v250, v209
    v_perm_b32 v236, v250, v250, v210
    v_perm_b32 v237, v250, v250, v211
    s_nop 1
    v_mfma_f32_16x16x32_bf16 v[224:227], v[234:237], v[80:83], v[224:227]
    v_perm_b32 v238, v250, v250, v212
    v_perm_b32 v239, v250, v250, v213
    v_perm_b32 v240, v250, v250, v214
    v_perm_b32 v241, v250, v250, v215
    s_nop 1
    v_mfma_f32_16x16x32_bf16 v[224:227], v[238:241], v[84:87], v[224:227]
    v_perm_b32 v234, v251, v251, v208
    v_perm_b32 v235, v251, v251, v209
    v_perm_b32 v236, v251, v251, v210
    v_perm_b32 v237, v251, v251, v211
    s_nop 1
    v_mfma_f32_16x16x32_bf16 v[224:227], v[234:237], v[88:91], v[224:227]
    v_perm_b32 v238, v251, v251, v212
    v_perm_b32 v239, v251, v251, v213
    v_perm_b32 v240, v251, v251, v214
    v_perm_b32 v241, v251, v251, v215
    s_nop 1
    v_mfma_f32_16x16x32_bf16 v[224:227], v[238:241], v[92:95], v[224:227]
    s_nop 7
    v_cvt_pk_bf16_f32 v228, v224, v225
    v_cvt_pk_bf16_f32 v229, v226, v227
    v_min_u32 v228, -2, v228
    v_min_u32 v229, -2, v229
    v_mov_b32 v230, v228
    v_mov_b32 v231, v229
    s_nop 0
    v_permlane16_swap_b32 v228, v230
    v_permlane16_swap_b32 v229, v231
    s_mov_b32 exec_lo, 0xffff
    s_mov_b32 exec_hi, 0xffff
    buffer_store_dwordx4 v[228:231], v15, s[44:47], s10 offen sc1
    s_mov_b64 exec, -1
    s_lshr_b32 s10, s4, 4
    s_cmp_lg_u32 s10, s6
    s_cbranch_scc1 L_FINDONE
    s_cmp_lg_u32 s5, 0
    s_cbranch_scc1 L_FINDONE
    s_add_u32 s10, s8, 8192
    s_add_u32 s11, s10, 4096
    v_mov_b32 v10, 0x3f803f80
    v_perm_b32 v234, v10, v10, v4
    v_perm_b32 v235, v10, v10, v5
    v_mov_b32 v232, 0
    v_mov_b32 v233, 0
    v_mov_b32 v236, 0
    v_mov_b32 v237, 0
    buffer_load_dwordx4 v[96:99], v1, s[44:47], s10 offen offset:0 sc1
    buffer_load_dwordx4 v[100:103], v1, s[44:47], s10 offen offset:1024 sc1
    buffer_load_dwordx4 v[104:107], v1, s[44:47], s10 offen offset:2048 sc1
    buffer_load_dwordx4 v[108:111], v1, s[44:47], s10 offen offset:3072 sc1
    buffer_load_dwordx4 v[112:115], v1, s[44:47], s11 offen offset:0 sc1
    buffer_load_dwordx4 v[116:119], v1, s[44:47], s11 offen offset:1024 sc1
    buffer_load_dwordx4 v[120:123], v1, s[44:47], s11 offen offset:2048 sc1
    buffer_load_dwordx4 v[124:127], v1, s[44:47], s11 offen offset:3072 sc1
L_spin_40:
    buffer_load_dwordx4 v[128:131], v1, s[44:47], s10 offen offset:0 sc1
    buffer_load_dwordx4 v[132:135], v1, s[44:47], s10 offen offset:1024 sc1
    buffer_load_dwordx4 v[136:139], v1, s[44:47], s10 offen offset:2048 sc1
    buffer_load_dwordx4 v[140:143], v1, s[44:47], s10 offen offset:3072 sc1
    buffer_load_dwordx4 v[144:147], v1, s[44:47], s11 offen offset:0 sc1
    buffer_load_dwordx4 v[148:151], v1, s[44:47], s11 offen offset:1024 sc1
    buffer_load_dwordx4 v[152:155], v1, s[44:47], s11 offen offset:2048 sc1
    buffer_load_dwordx4 v[156:159], v1, s[44:47], s11 offen offset:3072 sc1
    s_waitcnt vmcnt(15)
    v_mfma_f32_16x16x32_bf16 v[224:227], v[234:237], v[96:99], 0
    v_mfma_f32_16x16x32_bf16 v[228:231], v[232:235], v[96:99], 0
    v_max3_u32 v10, v96, v97, v98
    v_max_u32 v10, v10, v99
    s_waitcnt vmcnt(14)
    v_mfma_f32_16x16x32_bf16 v[224:227], v[234:237], v[100:103], v[224:227]
    v_mfma_f32_16x16x32_bf16 v[228:231], v[232:235], v[100:103], v[228:231]
    v_max3_u32 v10, v10, v100, v101
    v_max3_u32 v10, v10, v102, v103
    s_waitcnt vmcnt(13)
    v_mfma_f32_16x16x32_bf16 v[224:227], v[234:237], v[104:107], v[224:227]
    v_mfma_f32_16x16x32_bf16 v[228:231], v[232:235], v[104:107], v[228:231]
    v_max3_u32 v10, v10, v104, v105
    v_max3_u32 v10, v10, v106, v107
    s_waitcnt vmcnt(12)
    v_mfma_f32_16x16x32_bf16 v[224:227], v[234:237], v[108:111], v[224:227]
    v_mfma_f32_16x16x32_bf16 v[228:231], v[232:235], v[108:111], v[228:231]
    v_max3_u32 v10, v10, v108, v109
    v_max3_u32 v10, v10, v110, v111
    s_waitcnt vmcnt(11)
    v_mfma_f32_16x16x32_bf16 v[224:227], v[234:237], v[112:115], v[224:227]
    v_mfma_f32_16x16x32_bf16 v[228:231], v[232:235], v[112:115], v[228:231]
    v_max3_u32 v10, v10, v112, v113
    v_max3_u32 v10, v10, v114, v115
    s_waitcnt vmcnt(10)
    v_mfma_f32_16x16x32_bf16 v[224:227], v[234:237], v[116:119], v[224:227]
    v_mfma_f32_16x16x32_bf16 v[228:231], v[232:235], v[116:119], v[228:231]
    v_max3_u32 v10, v10, v116, v117
    v_max3_u32 v10, v10, v118, v119
    s_waitcnt vmcnt(9)
    v_mfma_f32_16x16x32_bf16 v[224:227], v[234:237], v[120:123], v[224:227]
    v_mfma_f32_16x16x32_bf16 v[228:231], v[232:235], v[120:123], v[228:231]
    v_max3_u32 v10, v10, v120, v121
    v_max3_u32 v10, v10, v122, v123
    s_waitcnt vmcnt(8)
    v_mfma_f32_16x16x32_bf16 v[224:227], v[234:237], v[124:127], v[224:227]
    v_mfma_f32_16x16x32_bf16 v[228:231], v[232:235], v[124:127], v[228:231]
    v_max3_u32 v10, v10, v124, v125
    v_max3_u32 v10, v10, v126, v127
    v_cmp_eq_u32 vcc, -1, v10
    s_cbranch_vccz L_ok_41
    buffer_load_dwordx4 v[96:99], v1, s[44:47], s10 offen offset:0 sc1
    buffer_load_dwordx4 v[100:103], v1, s[44:47], s10 offen offset:1024 sc1
    buffer_load_dwordx4 v[104:107], v1, s[44:47], s10 offen offset:2048 sc1
    buffer_load_dwordx4 v[108:111], v1, s[44:47], s10 offen offset:3072 sc1
    buffer_load_dwordx4 v[112:115], v1, s[44:47], s11 offen offset:0 sc1
    buffer_load_dwordx4 v[116:119], v1, s[44:47], s11 offen offset:1024 sc1
    buffer_load_dwordx4 v[120:123], v1, s[44:47], s11 offen offset:2048 sc1
    buffer_load_dwordx4 v[124:127], v1, s[44:47], s11 offen offset:3072 sc1
    s_waitcnt vmcnt(15)
    v_mfma_f32_16x16x32_bf16 v[224:227], v[234:237], v[128:131], 0
    v_mfma_f32_16x16x32_bf16 v[228:231], v[232:235], v[128:131], 0
    v_max3_u32 v10, v128, v129, v130
    v_max_u32 v10, v10, v131
    s_waitcnt vmcnt(14)
    v_mfma_f32_16x16x32_bf16 v[224:227], v[234:237], v[132:135], v[224:227]
    v_mfma_f32_16x16x32_bf16 v[228:231], v[232:235], v[132:135], v[228:231]
    v_max3_u32 v10, v10, v132, v133
    v_max3_u32 v10, v10, v134, v135
    s_waitcnt vmcnt(13)
    v_mfma_f32_16x16x32_bf16 v[224:227], v[234:237], v[136:139], v[224:227]
    v_mfma_f32_16x16x32_bf16 v[228:231], v[232:235], v[136:139], v[228:231]
    v_max3_u32 v10, v10, v136, v137
    v_max3_u32 v10, v10, v138, v139
    s_waitcnt vmcnt(12)
    v_mfma_f32_16x16x32_bf16 v[224:227], v[234:237], v[140:143], v[224:227]
    v_mfma_f32_16x16x32_bf16 v[228:231], v[232:235], v[140:143], v[228:231]
    v_max3_u32 v10, v10, v140, v141
    v_max3_u32 v10, v10, v142, v143
    s_waitcnt vmcnt(11)
    v_mfma_f32_16x16x32_bf16 v[224:227], v[234:237], v[144:147], v[224:227]
    v_mfma_f32_16x16x32_bf16 v[228:231], v[232:235], v[144:147], v[228:231]
    v_max3_u32 v10, v10, v144, v145
    v_max3_u32 v10, v10, v146, v147
    s_waitcnt vmcnt(10)
    v_mfma_f32_16x16x32_bf16 v[224:227], v[234:237], v[148:151], v[224:227]
    v_mfma_f32_16x16x32_bf16 v[228:231], v[232:235], v[148:151], v[228:231]
    v_max3_u32 v10, v10, v148, v149
    v_max3_u32 v10, v10, v150, v151
    s_waitcnt vmcnt(9)
    v_mfma_f32_16x16x32_bf16 v[224:227], v[234:237], v[152:155], v[224:227]
    v_mfma_f32_16x16x32_bf16 v[228:231], v[232:235], v[152:155], v[228:231]
    v_max3_u32 v10, v10, v152, v153
    v_max3_u32 v10, v10, v154, v155
    s_waitcnt vmcnt(8)
    v_mfma_f32_16x16x32_bf16 v[224:227], v[234:237], v[156:159], v[224:227]
    v_mfma_f32_16x16x32_bf16 v[228:231], v[232:235], v[156:159], v[228:231]
    v_max3_u32 v10, v10, v156, v157
    v_max3_u32 v10, v10, v158, v159
    v_cmp_eq_u32 vcc, -1, v10
    s_cbranch_vccz L_ok_41
    s_sub_u32 s14, s14, 1
    s_cbranch_scc0 L_spin_40
L_ok_41:
    s_nop 2
    v_add_f32_dpp v224, v224, v224 row_ror:8 row_mask:0xf bank_mask:0xf
    v_add_f32_dpp v225, v225, v225 row_ror:8 row_mask:0xf bank_mask:0xf
    v_add_f32_dpp v226, v226, v226 row_ror:8 row_mask:0xf bank_mask:0xf
    v_add_f32_dpp v227, v227, v227 row_ror:8 row_mask:0xf bank_mask:0xf
    v_add_f32_dpp v228, v228, v228 row_ror:8 row_mask:0xf bank_mask:0xf
    v_add_f32_dpp v229, v229, v229 row_ror:8 row_mask:0xf bank_mask:0xf
    v_add_f32_dpp v230, v230, v230 row_ror:8 row_mask:0xf bank_mask:0xf
    v_add_f32_dpp v231, v231, v231 row_ror:8 row_mask:0xf bank_mask:0xf
    v_cvt_pk_bf16_f32 v16, v224, v225
    v_cvt_pk_bf16_f32 v17, v226, v227
    v_cvt_pk_bf16_f32 v18, v228, v229
    v_cvt_pk_bf16_f32 v19, v230, v231
    s_bfe_u32 s10, s4, 0x10003
    s_lshl_b32 s10, s10, 11
    s_and_b32 s11, s4, 7
    s_lshl_b32 s11, s11, 7
    s_add_u32 s10, s10, s11
    s_lshl_b32 s11, s6, 10
    s_add_u32 s10, s10, s11
    s_mov_b64 exec, 0xff
    buffer_store_dwordx4 v[16:19], v1, s[64:67], s10 offen sc1
    s_cmp_lg_u32 s4, 16
    s_cbranch_scc1 L_FINDONE
    s_mov_b64 exec, 1
    v_mov_b32 v10, s94
    s_mov_b32 s10, 393216
    buffer_store_dword v10, off, s[44:47], s10 sc1
L_FINDONE:
    s_endpgm
L_C_REST:
    v_lshlrev_b32 v8, 4, v0
    s_waitcnt lgkmcnt(0)
    s_load_dword s94, s[42:43], 0x60000
    s_mov_b32 s44, s42
    s_mov_b32 s45, s43
    s_mov_b32 s46, 0x500000
    s_mov_b32 s47, 0x20000
    s_mov_b32 s60, s36
    s_mov_b32 s61, s37
    s_mov_b32 s62, 0x400000
    s_mov_b32 s63, 0x20000
    s_mov_b32 s64, s38
    s_mov_b32 s65, s39
    s_mov_b32 s66, 0x1000
    s_mov_b32 s67, 0x20000
    v_mov_b32 v16, -1
    v_mov_b32 v17, -1
    v_mov_b32 v18, -1
    v_mov_b32 v19, -1
    s_and_b32 s10, s4, 62
    s_lshl_b32 s10, s10, 14
    s_and_b32 s11, s4, 1
    s_mul_i32 s11, s11, 3072
    s_add_u32 s10, s10, s11
    s_add_u32 s10, s10, 1048576
    s_cmp_eq_u32 s3, 0
    s_cbranch_scc1 L_two_43
    s_cmp_eq_u32 s3, 1
    s_cbranch_scc1 L_skip_42
    s_cmp_ge_u32 s4, 32
    s_cbranch_scc1 L_skip_42
    s_lshl_b32 s10, s4, 14
    s_lshl_b32 s11, s3, 12
    s_add_u32 s10, s10, s11
    s_add_u32 s10, s10, 1048576
    buffer_store_dwordx4 v[16:19], v8, s[44:47], s10 offen offset:3072 sc1
L_two_43:
    buffer_store_dwordx4 v[16:19], v8, s[44:47], s10 offen offset:0 sc1
    buffer_store_dwordx4 v[16:19], v8, s[44:47], s10 offen offset:1024 sc1
    buffer_store_dwordx4 v[16:19], v8, s[44:47], s10 offen offset:2048 sc1
L_skip_42:
    s_mov_b32 s15, 0x3e0293ee
    s_mov_b32 s14, 20000
    v_and_b32 v9, 3, v0
    v_lshlrev_b32 v9, 2, v9
    v_bfe_u32 v10, v0, 2, 2
    v_or_b32 v9, v9, v10
    v_lshrrev_b32 v10, 5, v0
    v_xor_b32 v9, v9, v10
    v_lshlrev_b32 v9, 4, v9
    v_and_b32 v10, 31, v0
    v_lshl_add_u32 v1, v10, 10, v9
    v_add_u32 v3, 131072, v1
    s_lshl_b32 s10, s3, 15
    v_add_u32 v1, s10, v1
    v_lshrrev_b32 v10, 5, v0
    v_bfe_u32 v9, v0, 2, 2
    v_lshl_add_u32 v11, v10, 2, v9
    v_lshlrev_b32 v2, 10, v11
    v_bfe_u32 v11, v0, 4, 1
    v_lshlrev_b32 v11, 1, v11
    v_bfe_u32 v12, v0, 1, 1
    v_or_b32 v11, v11, v12
    v_xor_b32 v11, v11, v10
    v_lshl_add_u32 v11, v9, 2, v11
    v_lshl_add_u32 v2, v11, 4, v2
    v_and_b32 v11, 1, v0
    v_lshl_add_u32 v2, v11, 3, v2
    s_lshl_b32 s10, s3, 8
    v_add_u32 v2, s10, v2
    s_waitcnt lgkmcnt(0)
    s_add_u32 s94, s94, 1
    s_xor_b32 s95, s94, 0x5bd1e995
    v_xor_b32 v48, 0, v2
    v_xor_b32 v49, 32, v2
    v_add_u32 v49, 8192, v49
    v_xor_b32 v50, 64, v2
    v_xor_b32 v51, 96, v2
    v_add_u32 v51, 8192, v51
    v_xor_b32 v52, 128, v2
    v_xor_b32 v53, 160, v2
    v_add_u32 v53, 8192, v53
    v_xor_b32 v54, 192, v2
    v_xor_b32 v55, 224, v2
    v_add_u32 v55, 8192, v55
    s_and_b32 s9, s4, 7
    s_lshl_b32 s9, s9, 11
    s_add_u32 s9, s9, 524288
    v_lshlrev_b32 v26, 3, v0
    s_lshr_b32 s70, s4, 5
    s_lshl_b32 s70, s70, 15
    s_lshl_b32 s71, s3, 13
    s_add_u32 s70, s70, s71
    s_add_u32 s70, s70, 131072
    s_add_u32 s71, s70, 4096
    s_barrier
    ds_read_b64_tr_b16 v[128:129], v48 offset:0
    ds_read_b64_tr_b16 v[130:131], v49 offset:0
    ds_read_b64_tr_b16 v[132:133], v50 offset:0
    ds_read_b64_tr_b16 v[134:135], v51 offset:0
    ds_read_b64_tr_b16 v[136:137], v52 offset:0
    ds_read_b64_tr_b16 v[138:139], v53 offset:0
    ds_read_b64_tr_b16 v[140:141], v54 offset:0
    ds_read_b64_tr_b16 v[142:143], v55 offset:0
    ds_read_b64_tr_b16 v[144:145], v48 offset:16384
    ds_read_b64_tr_b16 v[146:147], v49 offset:16384
    ds_read_b64_tr_b16 v[148:149], v50 offset:16384
    ds_read_b64_tr_b16 v[150:151], v51 offset:16384
    ds_read_b64_tr_b16 v[152:153], v52 offset:16384
    ds_read_b64_tr_b16 v[154:155], v53 offset:16384
    ds_read_b64_tr_b16 v[156:157], v54 offset:16384
    s_waitcnt lgkmcnt(12)
    ds_read_b64_tr_b16 v[158:159], v55 offset:16384
    s_waitcnt lgkmcnt(0)
    s_waitcnt vmcnt(0)
    s_barrier
    s_cmp_lg_u32 s3, 0
    s_cbranch_scc1 L_skip_44
    s_lshr_b32 s12, s4, 3
    s_and_b32 s13, s4, 7
    s_add_u32 s13, s13, 8
    v_mov_b32 v16, s94
    v_mov_b32 v17, s95
    s_lshl_b32 s10, s12, 7
    s_lshl_b32 s11, s13, 3
    s_add_u32 s10, s10, s11
    s_add_u32 s10, s10, 327680
    s_mov_b64 exec, 1
    buffer_store_dwordx2 v[16:17], off, s[44:47], s10 sc1
    s_mov_b64 exec, -1
    v_lshlrev_b32 v30, 11, v0
    v_mov_b32 v28, s94
    v_mov_b32 v29, s95
    s_lshl_b32 s10, s4, 3
    s_add_u32 s10, s10, 525312
    s_mov_b64 exec, 255
    buffer_store_dwordx2 v[28:29], v30, s[44:47], s10 offen sc1
    s_mov_b64 exec, -1
L_skip_44:
    ds_read_b64_tr_b16 v[160:161], v48 offset:32768
    ds_read_b64_tr_b16 v[162:163], v49 offset:32768
    ds_read_b64_tr_b16 v[164:165], v50 offset:32768
    ds_read_b64_tr_b16 v[166:167], v51 offset:32768
    ds_read_b64_tr_b16 v[168:169], v52 offset:32768
    ds_read_b64_tr_b16 v[170:171], v53 offset:32768
    ds_read_b64_tr_b16 v[172:173], v54 offset:32768
    ds_read_b64_tr_b16 v[174:175], v55 offset:32768
    ds_read_b64_tr_b16 v[176:177], v48 offset:49152
    ds_read_b64_tr_b16 v[178:179], v49 offset:49152
    ds_read_b64_tr_b16 v[180:181], v50 offset:49152
    ds_read_b64_tr_b16 v[182:183], v51 offset:49152
    ds_read_b64_tr_b16 v[184:185], v52 offset:49152
    ds_read_b64_tr_b16 v[186:187], v53 offset:49152
    ds_read_b64_tr_b16 v[188:189], v54 offset:49152
    s_waitcnt lgkmcnt(12)
    ds_read_b64_tr_b16 v[190:191], v55 offset:49152
    s_waitcnt lgkmcnt(0)
    s_barrier
    s_cmp_lg_u32 s3, 0
    s_cbranch_scc1 L_skip_45
    buffer_load_dwordx2 v[20:21], v26, s[44:47], s9 offen offset:0 sc1
    buffer_load_dwordx2 v[22:23], v26, s[44:47], s9 offen offset:512 sc1
    buffer_load_dwordx2 v[24:25], v26, s[44:47], s9 offen offset:1024 sc1
L_skip_45:
    v_add_u32 v48, 65536, v48
    v_add_u32 v49, 65536, v49
    v_add_u32 v50, 65536, v50
    v_add_u32 v51, 65536, v51
    v_add_u32 v52, 65536, v52
    v_add_u32 v53, 65536, v53
    v_add_u32 v54, 65536, v54
    v_add_u32 v55, 65536, v55
    ds_read_b64_tr_b16 v[192:193], v48 offset:0
    ds_read_b64_tr_b16 v[194:195], v49 offset:0
    ds_read_b64_tr_b16 v[196:197], v50 offset:0
    ds_read_b64_tr_b16 v[198:199], v51 offset:0
    ds_read_b64_tr_b16 v[200:201], v52 offset:0
    ds_read_b64_tr_b16 v[202:203], v53 offset:0
    ds_read_b64_tr_b16 v[204:205], v54 offset:0
    ds_read_b64_tr_b16 v[206:207], v55 offset:0
    ds_read_b64_tr_b16 v[208:209], v48 offset:16384
    ds_read_b64_tr_b16 v[210:211], v49 offset:16384
    ds_read_b64_tr_b16 v[212:213], v50 offset:16384
    ds_read_b64_tr_b16 v[214:215], v51 offset:16384
    ds_read_b64_tr_b16 v[216:217], v52 offset:16384
    ds_read_b64_tr_b16 v[218:219], v53 offset:16384
    ds_read_b64_tr_b16 v[220:221], v54 offset:16384
    s_waitcnt lgkmcnt(12)
    ds_read_b64_tr_b16 v[222:223], v55 offset:16384
    s_waitcnt lgkmcnt(0)
    s_barrier
    ds_read_b64_tr_b16 v[224:225], v48 offset:32768
    ds_read_b64_tr_b16 v[226:227], v49 offset:32768
    ds_read_b64_tr_b16 v[228:229], v50 offset:32768
    ds_read_b64_tr_b16 v[230:231], v51 offset:32768
    ds_read_b64_tr_b16 v[232:233], v52 offset:32768
    ds_read_b64_tr_b16 v[234:235], v53 offset:32768
    ds_read_b64_tr_b16 v[236:237], v54 offset:32768
    ds_read_b64_tr_b16 v[238:239], v55 offset:32768
    ds_read_b64_tr_b16 v[240:241], v48 offset:49152
    ds_read_b64_tr_b16 v[242:243], v49 offset:49152
    ds_read_b64_tr_b16 v[244:245], v50 offset:49152
    ds_read_b64_tr_b16 v[246:247], v51 offset:49152
    ds_read_b64_tr_b16 v[248:249], v52 offset:49152
    ds_read_b64_tr_b16 v[250:251], v53 offset:49152
    ds_read_b64_tr_b16 v[252:253], v54 offset:49152
    s_waitcnt lgkmcnt(12)
    ds_read_b64_tr_b16 v[254:255], v55 offset:49152
    s_waitcnt lgkmcnt(0)
    s_cmp_lg_u32 s3, 0
    s_cbranch_scc1 L_ok_47
L_spin_46:
    s_waitcnt vmcnt(0)
    v_cmp_ne_u64 vcc, s[94:95], v[20:21]
    v_cmp_ne_u64 s[12:13], s[94:95], v[22:23]
    s_nop 0
    s_or_b64 vcc, vcc, s[12:13]
    v_cmp_ne_u64 s[12:13], s[94:95], v[24:25]
    s_nop 0
    s_or_b64 vcc, vcc, s[12:13]
    s_cbranch_vccz L_ok_47
    buffer_load_dwordx2 v[20:21], v26, s[44:47], s9 offen offset:0 sc1
    buffer_load_dwordx2 v[22:23], v26, s[44:47], s9 offen offset:512 sc1
    buffer_load_dwordx2 v[24:25], v26, s[44:47], s9 offen offset:1024 sc1
    s_sub_u32 s14, s14, 1
    s_cbranch_scc0 L_spin_46
L_ok_47:
    s_barrier
    buffer_load_dwordx4 v[64:67], v8, s[44:47], s70 offen offset:0 sc1
    buffer_load_dwordx4 v[68:71], v8, s[44:47], s70 offen offset:1024 sc1
    buffer_load_dwordx4 v[72:75], v8, s[44:47], s70 offen offset:2048 sc1
    buffer_load_dwordx4 v[76:79], v8, s[44:47], s70 offen offset:3072 sc1
    buffer_load_dwordx4 v[80:83], v8, s[44:47], s71 offen offset:0 sc1
    buffer_load_dwordx4 v[84:87], v8, s[44:47], s71 offen offset:1024 sc1
    buffer_load_dwordx4 v[88:91], v8, s[44:47], s71 offen offset:2048 sc1
    buffer_load_dwordx4 v[92:95], v8, s[44:47], s71 offen offset:3072 sc1
    s_lshl_b32 s12, s3, 13
    s_add_u32 s12, s12, 131072
    s_and_b32 s13, s3, 1
    s_lshl_b32 s13, s13, 5
    v_xor_b32 v9, s13, v8
    v_add_u32 v9, s12, v9
L_spin_48:
    s_waitcnt vmcnt(0)
    v_max3_u32 v10, v64, v65, v66
    v_max3_u32 v10, v10, v67, v68
    v_max3_u32 v10, v10, v69, v70
    v_max3_u32 v10, v10, v71, v72
    v_max3_u32 v10, v10, v73, v74
    v_max3_u32 v10, v10, v75, v76
    v_max3_u32 v10, v10, v77, v78
    v_max_u32 v10, v10, v79
    v_max3_u32 v11, v80, v81, v82
    v_max3_u32 v11, v11, v83, v84
    v_max3_u32 v11, v11, v85, v86
    v_max3_u32 v11, v11, v87, v88
    v_max3_u32 v11, v11, v89, v90
    v_max3_u32 v11, v11, v91, v92
    v_max3_u32 v11, v11, v93, v94
    v_max_u32 v11, v11, v95
    v_max_u32 v10, v10, v11
    v_cmp_eq_u32 vcc, -1, v10
    s_cbranch_vccz L_ok_49
    buffer_load_dwordx4 v[64:67], v8, s[44:47], s70 offen offset:0 sc1
    buffer_load_dwordx4 v[68:71], v8, s[44:47], s70 offen offset:1024 sc1
    buffer_load_dwordx4 v[72:75], v8, s[44:47], s70 offen offset:2048 sc1
    buffer_load_dwordx4 v[76:79], v8, s[44:47], s70 offen offset:3072 sc1
    buffer_load_dwordx4 v[80:83], v8, s[44:47], s71 offen offset:0 sc1
    buffer_load_dwordx4 v[84:87], v8, s[44:47], s71 offen offset:1024 sc1
    buffer_load_dwordx4 v[88:91], v8, s[44:47], s71 offen offset:2048 sc1
    buffer_load_dwordx4 v[92:95], v8, s[44:47], s71 offen offset:3072 sc1
    s_sub_u32 s14, s14, 1
    s_cbranch_scc0 L_spin_48
L_ok_49:
    v_xor_b32 v6, 0, v9
    ds_write_b128 v6, v[64:67] offset:0
    v_xor_b32 v7, 64, v9
    ds_write_b128 v7, v[68:71] offset:1024
    v_xor_b32 v6, 128, v9
    ds_write_b128 v6, v[72:75] offset:2048
    v_xor_b32 v7, 192, v9
    ds_write_b128 v7, v[76:79] offset:3072
    v_xor_b32 v6, 16, v9
    ds_write_b128 v6, v[80:83] offset:4096
    v_xor_b32 v7, 80, v9
    ds_write_b128 v7, v[84:87] offset:5120
    v_xor_b32 v6, 144, v9
    ds_write_b128 v6, v[88:91] offset:6144
    v_xor_b32 v7, 208, v9
    ds_write_b128 v7, v[92:95] offset:7168
    s_waitcnt lgkmcnt(0)
    s_barrier
    v_add_u32 v8, 133120, v8
    v_and_b32 v11, 15, v0
    v_lshlrev_b32 v11, 5, v11
    v_bfe_u32 v9, v0, 4, 1
    v_lshl_add_u32 v11, v9, 10, v11
    v_add_u32 v11, 131072, v11
    s_lshl_b32 s10, s3, 7
    s_add_u32 s10, s10, 153600
    v_and_b32 v9, 31, v0
    v_lshl_add_u32 v3, v9, 2, s10
    v_lshrrev_b32 v9, 5, v0
    v_lshl_add_u32 v1, v9, 4, s10
    v_xor_b32 v48, 0, v2
    v_xor_b32 v49, 32, v2
    v_add_u32 v49, 8192, v49
    v_xor_b32 v50, 64, v2
    v_xor_b32 v51, 96, v2
    v_add_u32 v51, 8192, v51
    v_xor_b32 v52, 128, v2
    v_xor_b32 v53, 160, v2
    v_add_u32 v53, 8192, v53
    v_xor_b32 v54, 192, v2
    v_xor_b32 v55, 224, v2
    v_add_u32 v55, 8192, v55
    s_barrier
    s_barrier
    s_barrier
    ds_read_b128 v[16:19], v8 offset:0
    ds_read_b128 v[20:23], v8 offset:1024
    ds_read_b128 v[24:27], v8 offset:2048
    ds_read_b128 v[28:31], v8 offset:3072
    ds_read_b128 v[32:35], v8 offset:4096
    ds_read_b128 v[36:39], v8 offset:5120
    ds_read_b128 v[40:43], v8 offset:6144
    ds_read_b128 v[44:47], v8 offset:7168
    s_waitcnt lgkmcnt(7)
    v_mfma_f32_32x32x16_bf16 v[64:79], v[16:19], v[128:131], 0
    v_mfma_f32_32x32x16_bf16 v[80:95], v[16:19], v[132:135], 0
    v_mfma_f32_32x32x16_bf16 v[96:111], v[16:19], v[136:139], 0
    v_mfma_f32_32x32x16_bf16 v[112:127], v[16:19], v[140:143], 0
    s_waitcnt lgkmcnt(6)
    v_mfma_f32_32x32x16_bf16 v[64:79], v[20:23], v[144:147], v[64:79]
    v_mfma_f32_32x32x16_bf16 v[80:95], v[20:23], v[148:151], v[80:95]
    v_mfma_f32_32x32x16_bf16 v[96:111], v[20:23], v[152:155], v[96:111]
    v_mfma_f32_32x32x16_bf16 v[112:127], v[20:23], v[156:159], v[112:127]
    s_waitcnt lgkmcnt(5)
    v_mfma_f32_32x32x16_bf16 v[64:79], v[24:27], v[160:163], v[64:79]
    v_mfma_f32_32x32x16_bf16 v[80:95], v[24:27], v[164:167], v[80:95]
    v_mfma_f32_32x32x16_bf16 v[96:111], v[24:27], v[168:171], v[96:111]
    v_mfma_f32_32x32x16_bf16 v[112:127], v[24:27], v[172:175], v[112:127]
    s_waitcnt lgkmcnt(4)
    v_mfma_f32_32x32x16_bf16 v[64:79], v[28:31], v[176:179], v[64:79]
    v_mfma_f32_32x32x16_bf16 v[80:95], v[28:31], v[180:183], v[80:95]
    v_mfma_f32_32x32x16_bf16 v[96:111], v[28:31], v[184:187], v[96:111]
    v_mfma_f32_32x32x16_bf16 v[112:127], v[28:31], v[188:191], v[112:127]
    s_waitcnt lgkmcnt(3)
    v_mfma_f32_32x32x16_bf16 v[64:79], v[32:35], v[192:195], v[64:79]
    v_mfma_f32_32x32x16_bf16 v[80:95], v[32:35], v[196:199], v[80:95]
    v_mfma_f32_32x32x16_bf16 v[96:111], v[32:35], v[200:203], v[96:111]
    v_mfma_f32_32x32x16_bf16 v[112:127], v[32:35], v[204:207], v[112:127]
    s_waitcnt lgkmcnt(2)
    v_mfma_f32_32x32x16_bf16 v[64:79], v[36:39], v[208:211], v[64:79]
    v_mfma_f32_32x32x16_bf16 v[80:95], v[36:39], v[212:215], v[80:95]
    v_mfma_f32_32x32x16_bf16 v[96:111], v[36:39], v[216:219], v[96:111]
    v_mfma_f32_32x32x16_bf16 v[112:127], v[36:39], v[220:223], v[112:127]
    s_waitcnt lgkmcnt(1)
    v_mfma_f32_32x32x16_bf16 v[64:79], v[40:43], v[224:227], v[64:79]
    v_mfma_f32_32x32x16_bf16 v[80:95], v[40:43], v[228:231], v[80:95]
    v_mfma_f32_32x32x16_bf16 v[96:111], v[40:43], v[232:235], v[96:111]
    v_mfma_f32_32x32x16_bf16 v[112:127], v[40:43], v[236:239], v[112:127]
    s_waitcnt lgkmcnt(0)
    v_mfma_f32_32x32x16_bf16 v[64:79], v[44:47], v[240:243], v[64:79]
    v_mfma_f32_32x32x16_bf16 v[80:95], v[44:47], v[244:247], v[80:95]
    v_mfma_f32_32x32x16_bf16 v[96:111], v[44:47], v[248:251], v[96:111]
    v_mfma_f32_32x32x16_bf16 v[112:127], v[44:47], v[252:255], v[112:127]
    s_barrier
    ds_read_b64_tr_b16 v[128:129], v48 offset:0
    ds_read_b64_tr_b16 v[130:131], v49 offset:0
    ds_read_b64_tr_b16 v[132:133], v50 offset:0
    ds_read_b64_tr_b16 v[134:135], v51 offset:0
    ds_read_b64_tr_b16 v[136:137], v52 offset:0
    ds_read_b64_tr_b16 v[138:139], v53 offset:0
    ds_read_b64_tr_b16 v[140:141], v54 offset:0
    ds_read_b64_tr_b16 v[142:143], v55 offset:0
    ds_read_b64_tr_b16 v[144:145], v48 offset:16384
    ds_read_b64_tr_b16 v[146:147], v49 offset:16384
    ds_read_b64_tr_b16 v[148:149], v50 offset:16384
    ds_read_b64_tr_b16 v[150:151], v51 offset:16384
    ds_read_b64_tr_b16 v[152:153], v52 offset:16384
    ds_read_b64_tr_b16 v[154:155], v53 offset:16384
    ds_read_b64_tr_b16 v[156:157], v54 offset:16384
    s_waitcnt lgkmcnt(12)
    ds_read_b64_tr_b16 v[158:159], v55 offset:16384
    ds_read_b64_tr_b16 v[160:161], v48 offset:32768
    ds_read_b64_tr_b16 v[162:163], v49 offset:32768
    s_waitcnt lgkmcnt(12)
    ds_read_b64_tr_b16 v[164:165], v50 offset:32768
    ds_read_b64_tr_b16 v[166:167], v51 offset:32768
    ds_read_b64_tr_b16 v[168:169], v52 offset:32768
    s_waitcnt lgkmcnt(12)
    ds_read_b64_tr_b16 v[170:171], v53 offset:32768
    ds_read_b64_tr_b16 v[172:173], v54 offset:32768
    ds_read_b64_tr_b16 v[174:175], v55 offset:32768
    s_waitcnt lgkmcnt(12)
    ds_read_b64_tr_b16 v[176:177], v48 offset:49152
    ds_read_b64_tr_b16 v[178:179], v49 offset:49152
    ds_read_b64_tr_b16 v[180:181], v50 offset:49152
    s_waitcnt lgkmcnt(12)
    ds_read_b64_tr_b16 v[182:183], v51 offset:49152
    ds_read_b64_tr_b16 v[184:185], v52 offset:49152
    ds_read_b64_tr_b16 v[186:187], v53 offset:49152
    s_waitcnt lgkmcnt(12)
    ds_read_b64_tr_b16 v[188:189], v54 offset:49152
    ds_read_b64_tr_b16 v[190:191], v55 offset:49152
    v_add_u32 v48, 65536, v48
    v_add_u32 v49, 65536, v49
    v_add_u32 v50, 65536, v50
    v_add_u32 v51, 65536, v51
    v_add_u32 v52, 65536, v52
    v_add_u32 v53, 65536, v53
    v_add_u32 v54, 65536, v54
    v_add_u32 v55, 65536, v55
    ds_read_b64_tr_b16 v[192:193], v48 offset:0
    s_waitcnt lgkmcnt(12)
    ds_read_b64_tr_b16 v[194:195], v49 offset:0
    ds_read_b64_tr_b16 v[196:197], v50 offset:0
    ds_read_b64_tr_b16 v[198:199], v51 offset:0
    s_waitcnt lgkmcnt(12)
    ds_read_b64_tr_b16 v[200:201], v52 offset:0
    ds_read_b64_tr_b16 v[202:203], v53 offset:0
    ds_read_b64_tr_b16 v[204:205], v54 offset:0
    s_waitcnt lgkmcnt(12)
    ds_read_b64_tr_b16 v[206:207], v55 offset:0
    ds_read_b64_tr_b16 v[208:209], v48 offset:16384
    ds_read_b64_tr_b16 v[210:211], v49 offset:16384
    s_waitcnt lgkmcnt(12)
    ds_read_b64_tr_b16 v[212:213], v50 offset:16384
    ds_read_b64_tr_b16 v[214:215], v51 offset:16384
    ds_read_b64_tr_b16 v[216:217], v52 offset:16384
    s_waitcnt lgkmcnt(12)
    ds_read_b64_tr_b16 v[218:219], v53 offset:16384
    ds_read_b64_tr_b16 v[220:221], v54 offset:16384
    ds_read_b64_tr_b16 v[222:223], v55 offset:16384
    s_waitcnt lgkmcnt(12)
    ds_read_b64_tr_b16 v[224:225], v48 offset:32768
    ds_read_b64_tr_b16 v[226:227], v49 offset:32768
    ds_read_b64_tr_b16 v[228:229], v50 offset:32768
    s_waitcnt lgkmcnt(12)
    ds_read_b64_tr_b16 v[230:231], v51 offset:32768
    ds_read_b64_tr_b16 v[232:233], v52 offset:32768
    ds_read_b64_tr_b16 v[234:235], v53 offset:32768
    s_waitcnt lgkmcnt(12)
    ds_read_b64_tr_b16 v[236:237], v54 offset:32768
    ds_read_b64_tr_b16 v[238:239], v55 offset:32768
    ds_read_b64_tr_b16 v[240:241], v48 offset:49152
    s_waitcnt lgkmcnt(12)
    ds_read_b64_tr_b16 v[242:243], v49 offset:49152
    ds_read_b64_tr_b16 v[244:245], v50 offset:49152
    ds_read_b64_tr_b16 v[246:247], v51 offset:49152
    s_waitcnt lgkmcnt(12)
    ds_read_b64_tr_b16 v[248:249], v52 offset:49152
    ds_read_b64_tr_b16 v[250:251], v53 offset:49152
    ds_read_b64_tr_b16 v[252:253], v54 offset:49152
    s_waitcnt lgkmcnt(12)
    ds_read_b64_tr_b16 v[254:255], v55 offset:49152
    s_waitcnt lgkmcnt(0)
    s_barrier
    ds_read_b128 v[16:19], v11 offset:0
    ds_read_b128 v[20:23], v11 offset:16
    s_waitcnt lgkmcnt(0)
    v_max3_f32 v9, v16, v17, v18
    v_max_f32 v9, v9, v19
    v_max3_f32 v4, v9, v20, v21
    v_max3_f32 v4, v4, v22, v23
    v_mul_f32 v9, s15, v9
    v_mul_f32 v4, s15, v4
    v_sub_f32 v9, v9, v4
    v_exp_f32 v9, v9
    ds_write_b32 v3, v9
    ds_read_b128 v[48:51], v1 offset:0
    ds_read_b128 v[52:55], v1 offset:32
    ds_read_b128 v[56:59], v1 offset:64
    ds_read_b128 v[60:63], v1 offset:96
    s_waitcnt lgkmcnt(0)
    v_mul_f32 v64, v64, v48
    v_mul_f32 v65, v65, v49
    v_mul_f32 v66, v66, v50
    v_mul_f32 v67, v67, v51
    v_mul_f32 v68, v68, v52
    v_mul_f32 v69, v69, v53
    v_mul_f32 v70, v70, v54
    v_mul_f32 v71, v71, v55
    v_mul_f32 v72, v72, v56
    v_mul_f32 v73, v73, v57
    v_mul_f32 v74, v74, v58
    v_mul_f32 v75, v75, v59
    v_mul_f32 v76, v76, v60
    v_mul_f32 v77, v77, v61
    v_mul_f32 v78, v78, v62
    v_mul_f32 v79, v79, v63
    v_mul_f32 v80, v80, v48
    v_mul_f32 v81, v81, v49
    v_mul_f32 v82, v82, v50
    v_mul_f32 v83, v83, v51
    v_mul_f32 v84, v84, v52
    v_mul_f32 v85, v85, v53
    v_mul_f32 v86, v86, v54
    v_mul_f32 v87, v87, v55
    v_mul_f32 v88, v88, v56
    v_mul_f32 v89, v89, v57
    v_mul_f32 v90, v90, v58
    v_mul_f32 v91, v91, v59
    v_mul_f32 v92, v92, v60
    v_mul_f32 v93, v93, v61
    v_mul_f32 v94, v94, v62
    v_mul_f32 v95, v95, v63
    v_mul_f32 v96, v96, v48
    v_mul_f32 v97, v97, v49
    v_mul_f32 v98, v98, v50
    v_mul_f32 v99, v99, v51
    v_mul_f32 v100, v100, v52
    v_mul_f32 v101, v101, v53
    v_mul_f32 v102, v102, v54
    v_mul_f32 v103, v103, v55
    v_mul_f32 v104, v104, v56
    v_mul_f32 v105, v105, v57
    v_mul_f32 v106, v106, v58
    v_mul_f32 v107, v107, v59
    v_mul_f32 v108, v108, v60
    v_mul_f32 v109, v109, v61
    v_mul_f32 v110, v110, v62
    v_mul_f32 v111, v111, v63
    v_mul_f32 v112, v112, v48
    v_mul_f32 v113, v113, v49
    v_mul_f32 v114, v114, v50
    v_mul_f32 v115, v115, v51
    v_mul_f32 v116, v116, v52
    v_mul_f32 v117, v117, v53
    v_mul_f32 v118, v118, v54
    v_mul_f32 v119, v119, v55
    v_mul_f32 v120, v120, v56
    v_mul_f32 v121, v121, v57
    v_mul_f32 v122, v122, v58
    v_mul_f32 v123, v123, v59
    v_mul_f32 v124, v124, v60
    v_mul_f32 v125, v125, v61
    v_mul_f32 v126, v126, v62
    v_mul_f32 v127, v127, v63
    s_barrier
    ds_read_b128 v[16:19], v8 offset:8192
    ds_read_b128 v[20:23], v8 offset:9216
    ds_read_b128 v[24:27], v8 offset:10240
    ds_read_b128 v[28:31], v8 offset:11264
    ds_read_b128 v[32:35], v8 offset:12288
    ds_read_b128 v[36:39], v8 offset:13312
    ds_read_b128 v[40:43], v8 offset:14336
    ds_read_b128 v[44:47], v8 offset:15360
    s_waitcnt lgkmcnt(7)
    v_mfma_f32_32x32x16_bf16 v[64:79], v[16:19], v[128:131], v[64:79]
    v_mfma_f32_32x32x16_bf16 v[80:95], v[16:19], v[132:135], v[80:95]
    v_mfma_f32_32x32x16_bf16 v[96:111], v[16:19], v[136:139], v[96:111]
    v_mfma_f32_32x32x16_bf16 v[112:127], v[16:19], v[140:143], v[112:127]
    s_waitcnt lgkmcnt(6)
    v_mfma_f32_32x32x16_bf16 v[64:79], v[20:23], v[144:147], v[64:79]
    v_mfma_f32_32x32x16_bf16 v[80:95], v[20:23], v[148:151], v[80:95]
    v_mfma_f32_32x32x16_bf16 v[96:111], v[20:23], v[152:155], v[96:111]
    v_mfma_f32_32x32x16_bf16 v[112:127], v[20:23], v[156:159], v[112:127]
    s_waitcnt lgkmcnt(5)
    v_mfma_f32_32x32x16_bf16 v[64:79], v[24:27], v[160:163], v[64:79]
    v_mfma_f32_32x32x16_bf16 v[80:95], v[24:27], v[164:167], v[80:95]
    v_mfma_f32_32x32x16_bf16 v[96:111], v[24:27], v[168:171], v[96:111]
    v_mfma_f32_32x32x16_bf16 v[112:127], v[24:27], v[172:175], v[112:127]
    s_waitcnt lgkmcnt(4)
    v_mfma_f32_32x32x16_bf16 v[64:79], v[28:31], v[176:179], v[64:79]
    v_mfma_f32_32x32x16_bf16 v[80:95], v[28:31], v[180:183], v[80:95]
    v_mfma_f32_32x32x16_bf16 v[96:111], v[28:31], v[184:187], v[96:111]
    v_mfma_f32_32x32x16_bf16 v[112:127], v[28:31], v[188:191], v[112:127]
    s_waitcnt lgkmcnt(3)
    v_mfma_f32_32x32x16_bf16 v[64:79], v[32:35], v[192:195], v[64:79]
    v_mfma_f32_32x32x16_bf16 v[80:95], v[32:35], v[196:199], v[80:95]
    v_mfma_f32_32x32x16_bf16 v[96:111], v[32:35], v[200:203], v[96:111]
    v_mfma_f32_32x32x16_bf16 v[112:127], v[32:35], v[204:207], v[112:127]
    s_waitcnt lgkmcnt(2)
    v_mfma_f32_32x32x16_bf16 v[64:79], v[36:39], v[208:211], v[64:79]
    v_mfma_f32_32x32x16_bf16 v[80:95], v[36:39], v[212:215], v[80:95]
    v_mfma_f32_32x32x16_bf16 v[96:111], v[36:39], v[216:219], v[96:111]
    v_mfma_f32_32x32x16_bf16 v[112:127], v[36:39], v[220:223], v[112:127]
    s_waitcnt lgkmcnt(1)
    v_mfma_f32_32x32x16_bf16 v[64:79], v[40:43], v[224:227], v[64:79]
    v_mfma_f32_32x32x16_bf16 v[80:95], v[40:43], v[228:231], v[80:95]
    v_mfma_f32_32x32x16_bf16 v[96:111], v[40:43], v[232:235], v[96:111]
    v_mfma_f32_32x32x16_bf16 v[112:127], v[40:43], v[236:239], v[112:127]
    s_waitcnt lgkmcnt(0)
    v_mfma_f32_32x32x16_bf16 v[64:79], v[44:47], v[240:243], v[64:79]
    v_mfma_f32_32x32x16_bf16 v[80:95], v[44:47], v[244:247], v[80:95]
    v_mfma_f32_32x32x16_bf16 v[96:111], v[44:47], v[248:251], v[96:111]
    v_mfma_f32_32x32x16_bf16 v[112:127], v[44:47], v[252:255], v[112:127]
    v_lshrrev_b32 v8, 5, v0
    v_lshlrev_b32 v8, 18, v8
    v_bfe_u32 v9, v0, 4, 1
    v_lshl_add_u32 v8, v9, 16, v8
    v_and_b32 v9, 15, v0
    v_lshl_add_u32 v8, v9, 4, v8
    s_lshl_b32 s10, s4, 10
    s_lshl_b32 s11, s3, 8
    s_add_u32 s10, s10, s11
    s_add_u32 s10, s10, 2097152
    v_cvt_pk_bf16_f32 v16, v64, v80
    s_nop 0
    v_cvt_pk_bf16_f32 v17, v96, v112
    v_cvt_pk_bf16_f32 v18, v65, v81
    v_cvt_pk_bf16_f32 v19, v97, v113
    v_cvt_pk_bf16_f32 v20, v66, v82
    v_cvt_pk_bf16_f32 v21, v98, v114
    v_cvt_pk_bf16_f32 v22, v67, v83
    v_cvt_pk_bf16_f32 v23, v99, v115
    v_permlane16_swap_b32 v16, v18
    v_permlane16_swap_b32 v17, v19
    buffer_store_dwordx4 v[16:19], v8, s[44:47], s10 offen sc1
    s_add_u32 s10, s10, 131072
    v_cvt_pk_bf16_f32 v24, v68, v84
    v_cvt_pk_bf16_f32 v25, v100, v116
    v_cvt_pk_bf16_f32 v26, v69, v85
    v_cvt_pk_bf16_f32 v27, v101, v117
    v_permlane16_swap_b32 v20, v22
    v_permlane16_swap_b32 v21, v23
    buffer_store_dwordx4 v[20:23], v8, s[44:47], s10 offen sc1
    s_add_u32 s10, s10, 393216
    v_cvt_pk_bf16_f32 v28, v70, v86
    v_cvt_pk_bf16_f32 v29, v102, v118
    v_cvt_pk_bf16_f32 v30, v71, v87
    v_cvt_pk_bf16_f32 v31, v103, v119
    v_permlane16_swap_b32 v24, v26
    v_permlane16_swap_b32 v25, v27
    buffer_store_dwordx4 v[24:27], v8, s[44:47], s10 offen sc1
    s_add_u32 s10, s10, 131072
    v_cvt_pk_bf16_f32 v32, v72, v88
    v_cvt_pk_bf16_f32 v33, v104, v120
    v_cvt_pk_bf16_f32 v34, v73, v89
    v_cvt_pk_bf16_f32 v35, v105, v121
    v_permlane16_swap_b32 v28, v30
    v_permlane16_swap_b32 v29, v31
    buffer_store_dwordx4 v[28:31], v8, s[44:47], s10 offen sc1
    s_add_u32 s10, s10, 393216
    v_cvt_pk_bf16_f32 v36, v74, v90
    v_cvt_pk_bf16_f32 v37, v106, v122
    v_cvt_pk_bf16_f32 v38, v75, v91
    v_cvt_pk_bf16_f32 v39, v107, v123
    v_permlane16_swap_b32 v32, v34
    v_permlane16_swap_b32 v33, v35
    buffer_store_dwordx4 v[32:35], v8, s[44:47], s10 offen sc1
    s_add_u32 s10, s10, 131072
    v_cvt_pk_bf16_f32 v40, v76, v92
    v_cvt_pk_bf16_f32 v41, v108, v124
    v_cvt_pk_bf16_f32 v42, v77, v93
    v_cvt_pk_bf16_f32 v43, v109, v125
    v_permlane16_swap_b32 v36, v38
    v_permlane16_swap_b32 v37, v39
    buffer_store_dwordx4 v[36:39], v8, s[44:47], s10 offen sc1
    s_add_u32 s10, s10, 393216
    v_cvt_pk_bf16_f32 v44, v78, v94
    v_cvt_pk_bf16_f32 v45, v110, v126
    v_cvt_pk_bf16_f32 v46, v79, v95
    v_cvt_pk_bf16_f32 v47, v111, v127
    v_permlane16_swap_b32 v40, v42
    v_permlane16_swap_b32 v41, v43
    buffer_store_dwordx4 v[40:43], v8, s[44:47], s10 offen sc1
    s_add_u32 s10, s10, 131072
    v_permlane16_swap_b32 v44, v46
    v_permlane16_swap_b32 v45, v47
    buffer_store_dwordx4 v[44:47], v8, s[44:47], s10 offen sc1
    s_cmp_lg_u32 s3, 0
    s_cbranch_scc1 L_skip_50
    ds_read_b128 v[48:51], v11 offset:20480
    v_lshlrev_b32 v9, 3, v0
    s_lshl_b32 s10, s4, 8
    s_add_u32 s10, s10, 262144
    s_waitcnt lgkmcnt(0)
    v_add_f32 v48, v48, v49
    v_add_f32 v50, v50, v51
    v_add_f32 v48, v48, v50
    v_mov_b32 v49, v48
    v_mov_b32 v48, v4
    s_mov_b32 exec_hi, 0
    buffer_store_dwordx2 v[48:49], v9, s[44:47], s10 offen sc1
    s_mov_b64 exec, -1
L_skip_50:
    s_mov_b32 s5, s3
    s_mov_b32 s6, 1
    v_mov_b32 v100, 155712
    v_mov_b32 v101, 1
    s_mov_b64 exec, 1
    s_waitcnt vmcnt(0)
    ds_add_rtn_u32 v102, v100, v101
    s_waitcnt lgkmcnt(0)
    v_cmp_eq_u32 vcc, 3, v102
    s_mov_b64 exec, -1
    s_cbranch_vccz L_skip_51
    v_lshlrev_b32 v98, 11, v0
    v_mov_b32 v96, s94
    v_mov_b32 v97, s95
    s_lshl_b32 s10, s4, 3
    s_add_u32 s10, s10, 525824
    s_mov_b64 exec, 255
    buffer_store_dwordx2 v[96:97], v98, s[44:47], s10 offen sc1
    s_mov_b64 exec, -1
    s_waitcnt vmcnt(0)
    v_mov_b32 v100, 155712
    v_mov_b32 v101, 1
    s_mov_b64 exec, 1
    ds_add_u32 v100, v101
    s_mov_b64 exec, -1
L_skip_51:
    v_lshrrev_b32 v2, 4, v0
    v_lshlrev_b32 v2, 14, v2
    v_and_b32 v11, 15, v0
    v_lshl_add_u32 v2, v11, 4, v2
    v_lshlrev_b32 v1, 4, v0
    s_lshl_b32 s7, s3, 11
    s_lshl_b32 s8, s4, 14
    s_add_u32 s8, s8, 1048576
    v_lshl_add_u32 v13, v0, 2, s7
    v_bfe_u32 v14, v0, 3, 1
    v_lshlrev_b32 v14, 7, v14
    v_lshrrev_b32 v11, 4, v0
    v_lshl_add_u32 v14, v11, 5, v14
    v_add_u32 v14, s7, v14
    v_lshrrev_b32 v15, 5, v0
    v_lshlrev_b32 v15, 17, v15
    v_bfe_u32 v11, v0, 3, 1
    v_lshl_add_u32 v15, v11, 14, v15
    v_and_b32 v11, 7, v0
    v_lshl_add_u32 v15, v11, 4, v15
    v_and_b32 v3, 1, v0
    v_cmp_eq_u32 vcc, 1, v3
    v_mov_b32 v8, 0x0c0c0100
    v_mov_b32 v3, 0x01000c0c
    v_cndmask_b32 v8, v8, v3, vcc
    v_add_u32 v9, 0x0202, v8
    v_mov_b32 v3, 0x03020c0c
    v_cndmask_b32 v9, v9, v3, vcc
    v_and_b32 v3, 2, v0
    v_cmp_eq_u32 vcc, 0, v3
    v_mov_b32 v3, 0x0c0c0c0c
    s_nop 0
    v_cndmask_b32 v4, v3, v8, vcc
    v_cndmask_b32 v5, v8, v3, vcc
    v_cndmask_b32 v6, v3, v9, vcc
    v_cndmask_b32 v7, v9, v3, vcc
    s_mov_b32 s72, 0x3030303
    s_mov_b32 s73, 0x3030303
    s_mov_b32 s74, 0xc0c0c0c
    s_mov_b32 s75, 0xc0c0c0c
    s_mov_b32 s76, 0x30303030
    s_mov_b32 s77, 0x30303030
    s_mov_b32 s78, 0xc0c0c0c0
    s_mov_b32 s79, 0xc0c0c0c0
    v_mov_b32 v3, 0x0c0c0c0c
    v_cndmask_b32 v208, v3, v8, s[72:73]
    v_cndmask_b32 v209, v3, v8, s[74:75]
    v_cndmask_b32 v210, v3, v8, s[76:77]
    v_cndmask_b32 v211, v3, v8, s[78:79]
    v_cndmask_b32 v212, v3, v9, s[72:73]
    v_cndmask_b32 v213, v3, v9, s[74:75]
    v_cndmask_b32 v214, v3, v9, s[76:77]
    v_cndmask_b32 v215, v3, v9, s[78:79]
    v_mov_b32 v100, 155712
    s_mov_b32 s14, 400000
L_spin_52:
    ds_read_b32 v101, v100
    s_waitcnt lgkmcnt(0)
    v_cmp_ne_u32 vcc, 5, v101
    s_cbranch_vccz L_ok_53
    s_sleep 2
    s_sub_u32 s14, s14, 1
    s_cbranch_scc0 L_spin_52
L_ok_53:
    s_lshl_b32 s10, s4, 16
    s_lshl_b32 s11, s5, 8
    s_add_u32 s10, s10, s11
    buffer_load_dwordx4 v[32:35], v2, s[60:63], s10 offen offset:0 nt
    buffer_load_dwordx4 v[36:39], v2, s[60:63], s10 offen offset:1024 nt
    buffer_load_dwordx4 v[40:43], v2, s[60:63], s10 offen offset:2048 nt
    buffer_load_dwordx4 v[44:47], v2, s[60:63], s10 offen offset:3072 nt
    s_add_u32 s10, s10, 4096
    buffer_load_dwordx4 v[48:51], v2, s[60:63], s10 offen offset:0 nt
    buffer_load_dwordx4 v[52:55], v2, s[60:63], s10 offen offset:1024 nt
    buffer_load_dwordx4 v[56:59], v2, s[60:63], s10 offen offset:2048 nt
    buffer_load_dwordx4 v[60:63], v2, s[60:63], s10 offen offset:3072 nt
    s_add_u32 s10, s10, 4096
    buffer_load_dwordx4 v[64:67], v2, s[60:63], s10 offen offset:0 nt
    buffer_load_dwordx4 v[68:71], v2, s[60:63], s10 offen offset:1024 nt
    buffer_load_dwordx4 v[72:75], v2, s[60:63], s10 offen offset:2048 nt
    buffer_load_dwordx4 v[76:79], v2, s[60:63], s10 offen offset:3072 nt
    s_add_u32 s10, s10, 4096
    buffer_load_dwordx4 v[80:83], v2, s[60:63], s10 offen offset:0 nt
    buffer_load_dwordx4 v[84:87], v2, s[60:63], s10 offen offset:1024 nt
    buffer_load_dwordx4 v[88:91], v2, s[60:63], s10 offen offset:2048 nt
    buffer_load_dwordx4 v[92:95], v2, s[60:63], s10 offen offset:3072 nt
    s_add_u32 s10, s10, 4096
    s_mov_b32 s14, 400000
    v_lshlrev_b32 v13, 2, v0
    v_subrev_u32 v14, s7, v14
    s_cmp_eq_u32 s3, 0
    s_cbranch_scc1 L_BPRE
    v_mov_b32 v100, 155776
    s_waitcnt vmcnt(0)
L_spin_54:
    ds_read_b32 v101, v100
    ds_read_b128 v[244:247], v14 offset:1024
    ds_read_b128 v[248:251], v14 offset:1040
    s_waitcnt lgkmcnt(0)
    v_cmp_ne_u32 vcc, 0, v101
    s_cbranch_vccnz L_CORE2
    s_sub_u32 s14, s14, 1
    s_cbranch_scc0 L_spin_54
    s_branch L_CORE2
L_BPRE:
    s_mov_b32 s14, 20000
    v_mov_b32 v100, 155776
    v_mov_b32 v101, 1
    v_bfe_u32 v10, v0, 4, 1
    v_mul_u32_u24 v10, 6144, v10
    v_and_b32 v11, 15, v0
    v_lshl_add_u32 v10, v11, 6, v10
    s_lshr_b32 s10, s4, 3
    s_mul_i32 s10, s10, 768
    s_bfe_u32 s11, s4, 0x20001
    s_lshl_b32 s11, s11, 4
    s_add_u32 s10, s10, s11
    s_add_u32 s10, s10, 294912
    s_mov_b32 s12, 0x0fff0fff
    s_mov_b32 s13, 0
    v_mov_b32 v21, 0xff
    s_mov_b64 exec, s[12:13]
L_spin_55:
    buffer_load_dwordx4 v[16:19], v10, s[44:47], s10 offen sc1
    s_waitcnt vmcnt(0)
    v_xor_b32 v22, s95, v16
    v_xor_b32 v17, s94, v17
    v_and_or_b32 v17, v22, v21, v17
    v_xor_b32 v22, s95, v18
    v_xor_b32 v19, s94, v19
    v_and_or_b32 v19, v22, v21, v19
    v_or_b32 v20, v17, v19
    v_cmp_ne_u32 vcc, 0, v20
    s_cbranch_vccz L_ok_56
    s_sleep 8
    s_sub_u32 s14, s14, 1
    s_cbranch_scc0 L_spin_55
L_ok_56:
    s_mov_b64 exec, -1
    v_and_b32 v17, 0xffffff00, v18
    v_and_b32 v16, 0xffffff00, v16
    v_mov_b32 v18, 0xff800000
    v_cndmask_b32 v16, v18, v16, s[12:13]
    v_cndmask_b32 v17, 0, v17, s[12:13]
    v_mov_b32 v18, v16
    s_nop 1
    v_max_f32_dpp v18, v18, v18 row_ror:1 row_mask:0xf bank_mask:0xf
    s_nop 1
    v_max_f32_dpp v18, v18, v18 row_ror:2 row_mask:0xf bank_mask:0xf
    s_nop 1
    v_max_f32_dpp v18, v18, v18 row_ror:4 row_mask:0xf bank_mask:0xf
    s_nop 1
    v_max_f32_dpp v18, v18, v18 row_ror:8 row_mask:0xf bank_mask:0xf
    v_sub_f32 v16, v16, v18
    v_exp_f32 v16, v16
    s_nop 0
    v_mul_f32 v17, v16, v17
    s_nop 1
    v_add_f32_dpp v17, v17, v17 row_ror:1 row_mask:0xf bank_mask:0xf
    s_nop 1
    v_add_f32_dpp v17, v17, v17 row_ror:2 row_mask:0xf bank_mask:0xf
    s_nop 1
    v_add_f32_dpp v17, v17, v17 row_ror:4 row_mask:0xf bank_mask:0xf
    s_nop 1
    v_add_f32_dpp v17, v17, v17 row_ror:8 row_mask:0xf bank_mask:0xf
    v_rcp_f32 v17, v17
    s_nop 0
    v_mul_f32 v16, v16, v17
    v_cvt_pk_bf16_f32 v16, v16, v16
    v_bfe_u32 v10, v0, 4, 1
    v_mul_u32_u24 v10, 24, v10
    v_and_b32 v11, 15, v0
    v_lshl_add_u32 v10, v11, 1, v10
    v_lshrrev_b32 v12, 4, v0
    v_mul_u32_u24 v12, 12, v12
    s_mov_b64 exec, s[12:13]
    ds_write_b16 v10, v16 offset:1536
    s_mov_b64 exec, -1
    ds_read_b32 v244, v12 offset:1536
    ds_read_b32 v245, v12 offset:1540
    ds_read_b32 v246, v12 offset:1544
    v_lshlrev_b32 v10, 7, v12
    v_lshl_add_u32 v10, v11, 4, v10
    s_and_b32 s10, s4, 62
    s_lshl_b32 s10, s10, 14
    s_add_u32 s10, s10, 1048576
    v_lshrrev_b32 v12, 5, v0
    v_lshlrev_b32 v12, 7, v12
    v_and_b32 v11, 7, v0
    v_lshl_add_u32 v12, v11, 4, v12
    v_bfe_u32 v11, v0, 4, 1
    v_lshl_add_u32 v12, v11, 3, v12
    s_and_b32 s11, s4, 1
    s_lshl_b32 s11, s11, 3
    s_lshl_b32 s12, 0x00ff00ff, s11
    s_mov_b32 s13, s12
    s_mov_b32 s70, 0x00030003
    s_mov_b32 s71, 0x03000300
    s_waitcnt lgkmcnt(0)
    v_perm_b32 v16, v244, v244, v8
    v_perm_b32 v17, v244, v244, v9
    v_perm_b32 v18, v245, v245, v8
    v_perm_b32 v19, v245, v245, v9
    v_perm_b32 v20, v246, v246, v8
    v_perm_b32 v21, v246, v246, v9
    v_cndmask_b32 v180, 0, v16, s[70:71]
    v_cndmask_b32 v184, 0, v17, s[70:71]
    v_cndmask_b32 v188, 0, v18, s[70:71]
    v_cndmask_b32 v192, 0, v19, s[70:71]
    v_cndmask_b32 v196, 0, v20, s[70:71]
    v_cndmask_b32 v200, 0, v21, s[70:71]
    s_lshl_b32 s70, s70, 2
    s_lshl_b32 s71, s71, 2
    v_cndmask_b32 v181, 0, v16, s[70:71]
    v_cndmask_b32 v185, 0, v17, s[70:71]
    v_cndmask_b32 v189, 0, v18, s[70:71]
    v_cndmask_b32 v193, 0, v19, s[70:71]
    v_cndmask_b32 v197, 0, v20, s[70:71]
    v_cndmask_b32 v201, 0, v21, s[70:71]
    s_lshl_b32 s70, s70, 2
    s_lshl_b32 s71, s71, 2
    v_cndmask_b32 v182, 0, v16, s[70:71]
    v_cndmask_b32 v186, 0, v17, s[70:71]
    v_cndmask_b32 v190, 0, v18, s[70:71]
    v_cndmask_b32 v194, 0, v19, s[70:71]
    v_cndmask_b32 v198, 0, v20, s[70:71]
    v_cndmask_b32 v202, 0, v21, s[70:71]
    s_lshl_b32 s70, s70, 2
    s_lshl_b32 s71, s71, 2
    v_cndmask_b32 v183, 0, v16, s[70:71]
    v_cndmask_b32 v187, 0, v17, s[70:71]
    v_cndmask_b32 v191, 0, v18, s[70:71]
    v_cndmask_b32 v195, 0, v19, s[70:71]
    v_cndmask_b32 v199, 0, v20, s[70:71]
    v_cndmask_b32 v203, 0, v21, s[70:71]
    buffer_load_dwordx4 v[104:107], v10, s[44:47], s10 offen offset:0 sc1
    buffer_load_dwordx4 v[108:111], v10, s[44:47], s10 offen offset:256 sc1
    buffer_load_dwordx4 v[112:115], v10, s[44:47], s10 offen offset:512 sc1
    buffer_load_dwordx4 v[116:119], v10, s[44:47], s10 offen offset:768 sc1
    buffer_load_dwordx4 v[120:123], v10, s[44:47], s10 offen offset:1024 sc1
    buffer_load_dwordx4 v[124:127], v10, s[44:47], s10 offen offset:1280 sc1
L_spin_57:
    buffer_load_dwordx4 v[128:131], v10, s[44:47], s10 offen offset:0 sc1
    buffer_load_dwordx4 v[132:135], v10, s[44:47], s10 offen offset:256 sc1
    buffer_load_dwordx4 v[136:139], v10, s[44:47], s10 offen offset:512 sc1
    buffer_load_dwordx4 v[140:143], v10, s[44:47], s10 offen offset:768 sc1
    buffer_load_dwordx4 v[144:147], v10, s[44:47], s10 offen offset:1024 sc1
    buffer_load_dwordx4 v[148:151], v10, s[44:47], s10 offen offset:1280 sc1
    s_waitcnt vmcnt(11)
    v_mfma_f32_16x16x32_bf16 v[224:227], v[180:183], v[104:107], 0
    v_max3_u32 v11, v104, v105, v106
    v_max_u32 v11, v11, v107
    s_waitcnt vmcnt(10)
    v_mfma_f32_16x16x32_bf16 v[224:227], v[184:187], v[108:111], v[224:227]
    v_max3_u32 v11, v11, v108, v109
    v_max3_u32 v11, v11, v110, v111
    s_waitcnt vmcnt(9)
    v_mfma_f32_16x16x32_bf16 v[224:227], v[188:191], v[112:115], v[224:227]
    v_max3_u32 v11, v11, v112, v113
    v_max3_u32 v11, v11, v114, v115
    s_waitcnt vmcnt(8)
    v_mfma_f32_16x16x32_bf16 v[224:227], v[192:195], v[116:119], v[224:227]
    v_max3_u32 v11, v11, v116, v117
    v_max3_u32 v11, v11, v118, v119
    s_waitcnt vmcnt(7)
    v_mfma_f32_16x16x32_bf16 v[224:227], v[196:199], v[120:123], v[224:227]
    v_max3_u32 v11, v11, v120, v121
    v_max3_u32 v11, v11, v122, v123
    s_waitcnt vmcnt(6)
    v_mfma_f32_16x16x32_bf16 v[224:227], v[200:203], v[124:127], v[224:227]
    v_max3_u32 v11, v11, v124, v125
    v_max3_u32 v11, v11, v126, v127
    v_cmp_eq_u32 vcc, -1, v11
    s_nop 0
    s_and_b64 vcc, vcc, s[12:13]
    s_cbranch_vccz L_ok_58
    buffer_load_dwordx4 v[104:107], v10, s[44:47], s10 offen offset:0 sc1
    buffer_load_dwordx4 v[108:111], v10, s[44:47], s10 offen offset:256 sc1
    buffer_load_dwordx4 v[112:115], v10, s[44:47], s10 offen offset:512 sc1
    buffer_load_dwordx4 v[116:119], v10, s[44:47], s10 offen offset:768 sc1
    buffer_load_dwordx4 v[120:123], v10, s[44:47], s10 offen offset:1024 sc1
    buffer_load_dwordx4 v[124:127], v10, s[44:47], s10 offen offset:1280 sc1
    s_waitcnt vmcnt(11)
    v_mfma_f32_16x16x32_bf16 v[224:227], v[180:183], v[128:131], 0
    v_max3_u32 v11, v128, v129, v130
    v_max_u32 v11, v11, v131
    s_waitcnt vmcnt(10)
    v_mfma_f32_16x16x32_bf16 v[224:227], v[184:187], v[132:135], v[224:227]
    v_max3_u32 v11, v11, v132, v133
    v_max3_u32 v11, v11, v134, v135
    s_waitcnt vmcnt(9)
    v_mfma_f32_16x16x32_bf16 v[224:227], v[188:191], v[136:139], v[224:227]
    v_max3_u32 v11, v11, v136, v137
    v_max3_u32 v11, v11, v138, v139
    s_waitcnt vmcnt(8)
    v_mfma_f32_16x16x32_bf16 v[224:227], v[192:195], v[140:143], v[224:227]
    v_max3_u32 v11, v11, v140, v141
    v_max3_u32 v11, v11, v142, v143
    s_waitcnt vmcnt(7)
    v_mfma_f32_16x16x32_bf16 v[224:227], v[196:199], v[144:147], v[224:227]
    v_max3_u32 v11, v11, v144, v145
    v_max3_u32 v11, v11, v146, v147
    s_waitcnt vmcnt(6)
    v_mfma_f32_16x16x32_bf16 v[224:227], v[200:203], v[148:151], v[224:227]
    v_max3_u32 v11, v11, v148, v149
    v_max3_u32 v11, v11, v150, v151
    v_cmp_eq_u32 vcc, -1, v11
    s_nop 0
    s_and_b64 vcc, vcc, s[12:13]
    s_cbranch_vccz L_ok_58
    s_sub_u32 s14, s14, 1
    s_cbranch_scc0 L_spin_57
L_ok_58:
    s_mov_b64 exec, s[12:13]
    s_nop 0
    v_cvt_pk_bf16_f32 v16, v224, v225
    v_cvt_pk_bf16_f32 v17, v226, v227
    ds_write_b64 v12, v[16:17] offset:1024
    s_mov_b64 exec, -1
    ds_write_b32 v100, v101
    s_branch L_CORE1
L_END:
    s_endpgm
.section .rodata,"a"
.p2align 6
.amdhsa_kernel concat_heads__compressed_kv_cla__gqa_block_cached__decode_kernel
  .amdhsa_next_free_vgpr 256
  .amdhsa_next_free_sgpr 102
  .amdhsa_accum_offset 256
  .amdhsa_group_segment_fixed_size 0
  .amdhsa_kernarg_size 112
  .amdhsa_user_sgpr_count 2
  .amdhsa_user_sgpr_kernarg_segment_ptr 1
  .amdhsa_system_sgpr_workgroup_id_x 1
.end_amdhsa_kernel
```
